```python
import torch

def _softmax(x, axis=-1):
    return torch.softmax(x, dim=axis)
def _gelu(x):
    return torch.nn.functional.gelu(x, approximate="tanh")
def _silu(x):
    return torch.nn.functional.silu(x)
def _sigmoid(x):
    return torch.sigmoid(x)
def _layernorm(x, axis=-1, eps=1e-5):
    m = x.mean(dim=axis, keepdim=True)
    v = x.var(dim=axis, keepdim=True, unbiased=False)
    return (x - m) / torch.sqrt(v + eps)
def _scatter_add(tgt, idx, src, axis=0):
    return tgt.clone().index_add_(axis, idx, src)
def _segment_sum(src, seg, n):
    out = torch.zeros((n,) + src.shape[1:], dtype=src.dtype)
    return out.index_add_(0, seg, src)
def _pad(x, pw):
    flat = tuple(v for pair in reversed(pw) for v in pair)
    return torch.nn.functional.pad(x, flat)

kernel_name = 'gated_mix__mha_block__glu_gated_glu__prompt'

def setup_inputs():

    _w = (lambda a: (lambda t: t.to(torch.bfloat16) if t.is_floating_point() else t)(torch.as_tensor(a)))
    def _A_setup():
        B, S, D, H = 1, 2048, 512, 32
        return {
            "x": _w((lambda *s: torch.randn(*s, dtype=torch.bfloat16) * 0.05)(B, S, D)),
            "wqkv": _w((lambda *s: torch.randn(*s, dtype=torch.bfloat16) * 0.8)(D, 3 * D)),
            "wo": _w((lambda *s: torch.randn(*s, dtype=torch.bfloat16) * 0.1)(D, D)),
        }
    _A_in = _A_setup()

    def _B_setup():
        B, S, D, F = 1, 2048, 512, 1376
        return {
            "x": _w((lambda *s: torch.randn(*s, dtype=torch.bfloat16) * 0.05)(B, S, D)),
            "w_gate": _w((lambda *s: torch.randn(*s, dtype=torch.bfloat16) * 0.8)(D, F)),
            "w_up": _w((lambda *s: torch.randn(*s, dtype=torch.bfloat16) * 0.05)(D, F)),
            "w_down": _w((lambda *s: torch.randn(*s, dtype=torch.bfloat16) * 0.05)(F, D)),
        }
    _B_in = _B_setup()

    return {
        "A_x": _A_in["x"],
        "A_wqkv": _A_in["wqkv"],
        "A_wo": _A_in["wo"],
        "B_x": _B_in["x"],
        "B_w_gate": _B_in["w_gate"],
        "B_w_up": _B_in["w_up"],
        "B_w_down": _B_in["w_down"],
        "gate_w": _w((lambda *s: torch.randn(*s, dtype=torch.bfloat16) * 0.05)(512) * 16.0),
    }

def reference(A_x, A_wqkv, A_wo, B_x, B_w_gate, B_w_up, B_w_down, gate_w):
    def _A_ref(x, wqkv, wo):
        B, S, D = x.shape
        H = 32
        Dh = D // H
        qkv = (lambda x, *d: x.permute(*d))((x @ wqkv).reshape(B, S, 3, H, Dh), 2, 0, 3, 1, 4)
        q, k, v = qkv[0], qkv[1], qkv[2]
        scores = torch.einsum("bhqd,bhkd->bhqk", q, k) * (Dh ** -0.5)
        p = _softmax(scores, axis=-1)
        o = torch.einsum("bhqk,bhkd->bhqd", p, v)
        return (lambda x, *d: x.permute(*d))(o, 0, 2, 1, 3).reshape(B, S, D) @ wo

    def _B_ref(x, w_gate, w_up, w_down):
        g = torch.einsum("bsd,df->bsf", x, w_gate)
        u = torch.einsum("bsd,df->bsf", x, w_up)
        h = _sigmoid(g) * u
        return torch.einsum("bsf,fd->bsd", h, w_down)

    x = A_x
    g = _sigmoid((x * gate_w).sum(-1, keepdims=True))
    a = _A_ref(x, A_wqkv, A_wo)
    b = _B_ref(x, B_w_gate, B_w_up, B_w_down)
    return g * a + (1 - g) * b
```

```asm
; @launch grid=(256,1,1) block=(768,1,1) lds=163840
.amdgcn_target "amdgcn-amd-amdhsa--gfx950"
.text
.globl gated_mix__mha_block__glu_gated_glu__prompt_kernel
.p2align 8
.type gated_mix__mha_block__glu_gated_glu__prompt_kernel,@function
gated_mix__mha_block__glu_gated_glu__prompt_kernel:
    s_cmp_ge_u32 s2, 256
    s_cbranch_scc1 L_end
    s_load_dwordx16 s[48:63], s[0:1], 0
    s_load_dwordx4 s[64:67], s[0:1], 64
    s_load_dwordx2 s[68:69], s[0:1], 80
    v_lshrrev_b32 v2, 6, v0
    v_and_b32 v1, 63, v0
    s_bfe_u32 s73, s2, 0x10003
    s_and_b32 s4, s2, 3
    s_lshl1_add_u32 s4, s4, s73
    s_bfe_u32 s5, s2, 0x10002
    v_readfirstlane_b32 s3, v2
    s_lshr_b32 s72, s2, 4
    s_lshl4_add_u32 s5, s5, s72
    s_lshl2_add_u32 s72, s73, s5
    s_and_b32 s72, s72, 7
    s_cmp_ge_u32 s3, 4
    s_cbranch_scc1 L_awave
    s_setprio 3
    v_lshrrev_b32 v19, 3, v1
    v_lshrrev_b32 v3, 4, v1
    v_and_b32 v7, 7, v1
    v_xor_b32 v3, v3, v7
    v_lshlrev_b32 v3, 4, v3
    v_lshl_add_u32 v16, v19, 10, v3
    v_xor_b32 v17, 64, v16
    v_add_u32 v17, 7168, v17
    v_bfe_u32 v20, v1, 2, 3
    v_mul_u32_u24 v19, 3072, v20
    v_lshrrev_b32 v3, 5, v1
    v_and_b32 v7, 3, v1
    v_lshlrev_b32 v7, 4, v7
    v_lshl_add_u32 v14, v3, 6, v7
    v_add_u32 v18, v19, v14
    v_add_u32 v19, 23552, v18
    v_xor_b32 v19, 32, v19
    s_lshl_b32 s74, s5, 16
    s_lshl_b32 s78, s3, 14
    s_add_u32 s74, s74, s78
    s_mul_i32 s75, s3, 49152
    s_lshl_b32 s78, s4, 7
    s_add_u32 s75, s75, s78
    s_lshl_b32 s76, s3, 11
    s_add_u32 s77, s76, 65536
    s_mov_b32 s73, s72
    s_mov_b32 s10, 0x200000
    s_mov_b32 s11, 0x20000
    s_mov_b32 s14, 0x180000
    s_mov_b32 s15, 0x20000
    s_waitcnt lgkmcnt(0)
    s_mov_b64 s[8:9], s[48:49]
    s_mov_b64 s[12:13], s[50:51]
    s_lshl_b32 s78, s72, 7
    s_mov_b32 m0, s76
    s_add_u32 s78, s78, s74
    buffer_load_dwordx4 v16, s[8:11], s78 offen lds
    buffer_load_dwordx4 v17, s[8:11], s78 offen offset:1024 lds
    s_add_u32 s76, s76, 8192
    s_add_u32 s72, s72, 1
    s_and_b32 s72, s72, 7
    s_bfe_u32 s78, s5, 0x10003
    s_lshl_b32 s47, s78, 5
    v_xor_b32 v27, s47, v18
    s_mul_i32 s79, s73, 196608
    s_add_u32 s79, s79, s75
    s_mul_i32 s47, s78, 24576
    s_add_u32 s79, s79, s47
    s_lshl_b32 s78, s78, 10
    s_add_u32 s78, s78, s77
    s_add_u32 m0, s78, 0
    s_nop 0
    buffer_load_dwordx4 v27, s[12:15], s79 offen offset:0 lds
    s_add_u32 m0, s78, 7168
    s_nop 0
    buffer_load_dwordx4 v27, s[12:15], s79 offen offset:1024 lds
    s_add_u32 m0, s78, 14336
    s_nop 0
    buffer_load_dwordx4 v27, s[12:15], s79 offen offset:2048 lds
    s_lshl_b32 s78, s72, 7
    s_mov_b32 m0, s76
    s_add_u32 s78, s78, s74
    buffer_load_dwordx4 v16, s[8:11], s78 offen lds
    buffer_load_dwordx4 v17, s[8:11], s78 offen offset:1024 lds
    s_add_u32 s76, s76, 8192
    s_add_u32 s72, s72, 1
    s_and_b32 s72, s72, 7
    s_add_u32 s44, s68, 0xdf0000
    s_addc_u32 s45, s69, 0
    s_load_dword s70, s[44:45], 0
    s_bfe_u32 s71, s2, 0x20003
    s_lshr_b32 s7, s2, 5
    s_and_b32 s6, s2, 7
    s_lshl2_add_u32 s6, s6, s71
    v_mov_b32 v4, 162816
    v_mov_b32 v5, 1
    s_mov_b32 s83, 200000
    v_lshlrev_b32 v2, 4, v1
    s_mov_b32 s80, s77
    s_add_u32 s81, s77, 98304
    s_add_u32 s46, s73, 1
    s_bfe_u32 s78, s5, 0x10003
    s_xor_b32 s78, s78, 1
    s_lshl_b32 s47, s78, 5
    v_xor_b32 v27, s47, v18
    s_mul_i32 s79, s73, 196608
    s_add_u32 s79, s79, s75
    s_mul_i32 s47, s78, 24576
    s_add_u32 s79, s79, s47
    s_lshl_b32 s78, s78, 10
    s_add_u32 s78, s78, s77
    s_add_u32 m0, s78, 0
    s_nop 0
    buffer_load_dwordx4 v27, s[12:15], s79 offen offset:0 lds
    s_add_u32 m0, s78, 7168
    s_nop 0
    buffer_load_dwordx4 v27, s[12:15], s79 offen offset:1024 lds
    s_add_u32 m0, s78, 14336
    s_nop 0
    buffer_load_dwordx4 v27, s[12:15], s79 offen offset:2048 lds
    s_add_u32 s73, s73, 1
    s_and_b32 s73, s73, 7
    s_add_u32 s77, s77, 24576
    s_cmp_eq_u32 s77, s81
    s_cmov_b32 s77, s80
    s_mul_i32 s79, s73, 196608
    s_mov_b32 m0, s77
    s_add_u32 s79, s79, s75
    buffer_load_dwordx4 v18, s[12:15], s79 offen offset:0 lds
    buffer_load_dwordx4 v19, s[12:15], s79 offen offset:1024 lds
    s_add_u32 m0, s77, 7168
    s_add_u32 s73, s73, 1
    buffer_load_dwordx4 v18, s[12:15], s79 offen offset:1024 lds
    buffer_load_dwordx4 v19, s[12:15], s79 offen offset:2048 lds
    s_add_u32 m0, s77, 14336
    s_and_b32 s73, s73, 7
    buffer_load_dwordx4 v18, s[12:15], s79 offen offset:2048 lds
    buffer_load_dwordx4 v19, s[12:15], s79 offen offset:3072 lds
    s_add_u32 s77, s77, 24576
    s_cmp_eq_u32 s77, s81
    s_cmov_b32 s77, s80
    s_mul_i32 s79, s73, 196608
    s_mov_b32 m0, s77
    s_add_u32 s79, s79, s75
    buffer_load_dwordx4 v18, s[12:15], s79 offen offset:0 lds
    buffer_load_dwordx4 v19, s[12:15], s79 offen offset:1024 lds
    s_add_u32 m0, s77, 7168
    s_add_u32 s73, s73, 1
    buffer_load_dwordx4 v18, s[12:15], s79 offen offset:1024 lds
    buffer_load_dwordx4 v19, s[12:15], s79 offen offset:2048 lds
    s_add_u32 m0, s77, 14336
    s_and_b32 s73, s73, 7
    buffer_load_dwordx4 v18, s[12:15], s79 offen offset:2048 lds
    buffer_load_dwordx4 v19, s[12:15], s79 offen offset:3072 lds
    s_lshl_b32 s78, s72, 7
    s_mov_b32 m0, s76
    s_add_u32 s78, s78, s74
    buffer_load_dwordx4 v16, s[8:11], s78 offen lds
    buffer_load_dwordx4 v17, s[8:11], s78 offen offset:1024 lds
    s_add_u32 s76, s76, 8192
    s_add_u32 s72, s72, 1
    s_and_b32 s72, s72, 7
    s_lshl_b32 s78, s72, 7
    s_mov_b32 m0, s76
    s_add_u32 s78, s78, s74
    buffer_load_dwordx4 v16, s[8:11], s78 offen lds
    buffer_load_dwordx4 v17, s[8:11], s78 offen offset:1024 lds
    s_add_u32 s76, s76, 8192
    s_add_u32 s72, s72, 1
    s_and_b32 s72, s72, 7
    s_waitcnt vmcnt(16)
    s_barrier
    s_waitcnt vmcnt(10)
    s_barrier
    s_cmp_lt_u32 s3, 2
    s_cselect_b32 s24, s56, s58
    s_cselect_b32 s25, s57, s59
    s_mov_b32 s26, 0x158000
    s_mov_b32 s27, 0x20000
    s_cselect_b32 s78, 0, 32
    v_lshrrev_b32 v3, 2, v1
    v_mul_u32_u24 v3, 2752, v3
    v_add_u32 v3, v3, v7
    v_and_b32 v20, 32, v1
    v_xor_b32 v20, v20, v3
    s_bfe_u32 s101, s5, 0x10003
    s_lshl1_add_u32 s101, s4, s101
    s_and_b32 s78, s2, 3
    s_mov_b32 s100, 0x120c0600
    s_cmp_eq_u32 s78, 1
    s_cmov_b32 s100, 0x26211c17
    s_cmp_eq_u32 s78, 2
    s_cmov_b32 s100, 0x3c36302b
    s_cmp_eq_u32 s78, 3
    s_cmov_b32 s100, 0x514c4742
    s_lshl_b32 s78, s101, 3
    s_lshr_b32 s100, s100, s78
    s_and_b32 s100, s100, 0xff
    s_lshr_b32 s97, 0xe07, s101
    s_and_b32 s97, s97, 1
    s_and_b32 s100, s100, -2
    s_mov_b32 s16, s68
    s_mov_b32 s17, s69
    s_mov_b32 s18, 0x1000000
    s_mov_b32 s19, 0x20000
    s_add_u32 s20, s68, 0x1000000
    s_addc_u32 s21, s69, 0
    s_mov_b32 s22, 0x560000
    s_mov_b32 s23, 0x20000
    s_mov_b32 s28, s60
    s_mov_b32 s29, s61
    s_mov_b32 s30, 0x158000
    s_mov_b32 s31, 0x20000
    s_mov_b32 s32, s52
    s_mov_b32 s33, s53
    s_mov_b32 s34, 0x80000
    s_mov_b32 s35, 0x20000
    s_mov_b32 s36, s64
    s_mov_b32 s37, s65
    s_mov_b32 s38, 0x200000
    s_mov_b32 s39, 0x20000
    s_mov_b32 s40, s62
    s_mov_b32 s41, s63
    s_mov_b32 s42, 0x400
    s_mov_b32 s43, 0x20000
    v_lshlrev_b32 v7, 7, v1
    s_lshl_b32 s55, s6, 12
    s_add_u32 s55, s55, 0xd28700
    v_add_u32 v61, s55, v7
    v_bfe_u32 v3, v1, 2, 3
    v_lshl_add_u32 v8, v3, 10, v14
    s_lshr_b32 s78, s3, 1
    s_lshl_b32 s78, s78, 6
    v_xor_b32 v8, s78, v8
    v_bfe_u32 v9, v1, 1, 2
    v_lshlrev_b32 v9, 3, v9
    v_bfe_u32 v11, v1, 3, 1
    v_lshl_add_u32 v9, v11, 6, v9
    s_lshr_b32 s78, s6, 2
    s_lshl_b32 s78, s78, 7
    s_lshr_b32 s55, s3, 1
    s_lshl_b32 s55, s55, 10
    s_add_u32 s78, s78, s55
    s_and_b32 s55, s3, 1
    s_lshl_b32 s55, s55, 5
    s_add_u32 s78, s78, s55
    s_add_u32 s78, s78, s71
    s_lshr_b32 s55, s6, 4
    s_lshl2_add_u32 s78, s55, s78
    v_add_u32 v9, s78, v9
    v_and_b32 v11, 1, v1
    v_lshlrev_b32 v11, 9, v11
    v_xor_b32 v9, v9, v11
    v_cmp_gt_u32 vcc, 16, v1
    v_lshlrev_b32 v9, 7, v9
    v_add_u32 v9, 0xd88000, v9
    v_cndmask_b32 v61, v61, v9, vcc
    s_mul_i32 s60, s3, 1441792
    s_lshl_b32 s78, s6, 11
    s_add_u32 s60, s60, s78
    s_lshl_b32 s62, s3, 17
    s_lshl_b32 s78, s7, 7
    s_add_u32 s62, s62, s78
    s_mul_i32 s63, s3, 360448
    s_add_u32 s63, s63, s78
    s_mul_i32 s64, s3, 7680
    s_add_u32 s64, s64, 132096
    v_lshrrev_b32 v3, 5, v1
    v_lshlrev_b32 v3, 2, v3
    v_bfe_u32 v9, v1, 2, 2
    v_add_u32 v3, v3, v9
    v_lshlrev_b32 v3, 6, v3
    v_bfe_u32 v9, v1, 4, 1
    v_lshl_add_u32 v3, v9, 5, v3
    v_and_b32 v9, 3, v1
    v_lshl_add_u32 v3, v9, 3, v3
    v_add_u32 v9, s64, v3
    v_lshrrev_b32 v3, 5, v1
    v_mul_u32_u24 v3, 768, v3
    v_add_u32 v63, v3, v9
    v_lshrrev_b32 v3, 4, v1
    v_lshlrev_b32 v3, 16, v3
    v_and_b32 v11, 15, v1
    v_lshl_add_u32 v60, v11, 7, v3
    v_and_b32 v13, 31, v1
    v_lshlrev_b32 v13, 2, v13
    s_lshr_b32 s57, s2, 3
    s_lshl2_add_u32 s57, s57, s3
    s_lshl_b32 s58, s57, 12
    s_mul_i32 s57, s57, 11008
    s_lshr_b32 s78, s3, 1
    s_lshr_b32 s66, 0xfef7, s101
    s_and_b32 s66, s66, 1
    s_or_b32 s66, s66, s78
    s_nop 0
    s_add_u32 s77, s77, 24576
    s_cmp_eq_u32 s77, s81
    s_cmov_b32 s77, s80
    s_mul_i32 s79, s73, 196608
    s_mov_b32 m0, s77
    s_add_u32 s79, s79, s75
    buffer_load_dwordx4 v18, s[12:15], s79 offen offset:0 lds
    buffer_load_dwordx4 v19, s[12:15], s79 offen offset:1024 lds
    s_add_u32 m0, s77, 7168
    s_add_u32 s73, s73, 1
    buffer_load_dwordx4 v18, s[12:15], s79 offen offset:1024 lds
    buffer_load_dwordx4 v19, s[12:15], s79 offen offset:2048 lds
    s_add_u32 m0, s77, 14336
    s_and_b32 s73, s73, 7
    buffer_load_dwordx4 v18, s[12:15], s79 offen offset:2048 lds
    buffer_load_dwordx4 v19, s[12:15], s79 offen offset:3072 lds
    s_waitcnt vmcnt(8)
    s_barrier
    s_lshl_b32 s78, s72, 7
    s_mov_b32 m0, s76
    s_add_u32 s78, s78, s74
    buffer_load_dwordx4 v16, s[8:11], s78 offen lds
    buffer_load_dwordx4 v17, s[8:11], s78 offen offset:1024 lds
    s_add_u32 s76, s76, 8192
    s_add_u32 s72, s72, 1
    s_and_b32 s72, s72, 7
    s_add_u32 s77, s77, 24576
    s_cmp_eq_u32 s77, s81
    s_cmov_b32 s77, s80
    s_mul_i32 s79, s73, 196608
    s_mov_b32 m0, s77
    s_add_u32 s79, s79, s75
    buffer_load_dwordx4 v18, s[12:15], s79 offen offset:0 lds
    buffer_load_dwordx4 v19, s[12:15], s79 offen offset:1024 lds
    s_add_u32 m0, s77, 7168
    s_add_u32 s73, s73, 1
    buffer_load_dwordx4 v18, s[12:15], s79 offen offset:1024 lds
    buffer_load_dwordx4 v19, s[12:15], s79 offen offset:2048 lds
    s_add_u32 m0, s77, 14336
    s_and_b32 s73, s73, 7
    buffer_load_dwordx4 v18, s[12:15], s79 offen offset:2048 lds
    buffer_load_dwordx4 v19, s[12:15], s79 offen offset:3072 lds
    s_waitcnt vmcnt(8)
    s_barrier
    s_lshl_b32 s78, s72, 7
    s_mov_b32 m0, s76
    s_add_u32 s78, s78, s74
    buffer_load_dwordx4 v16, s[8:11], s78 offen lds
    buffer_load_dwordx4 v17, s[8:11], s78 offen offset:1024 lds
    s_add_u32 s76, s76, 8192
    s_add_u32 s72, s72, 1
    s_and_b32 s72, s72, 7
    s_add_u32 s77, s77, 24576
    s_cmp_eq_u32 s77, s81
    s_cmov_b32 s77, s80
    s_mul_i32 s79, s73, 196608
    s_mov_b32 m0, s77
    s_add_u32 s79, s79, s75
    buffer_load_dwordx4 v18, s[12:15], s79 offen offset:0 lds
    buffer_load_dwordx4 v19, s[12:15], s79 offen offset:1024 lds
    s_add_u32 m0, s77, 7168
    s_add_u32 s73, s73, 1
    buffer_load_dwordx4 v18, s[12:15], s79 offen offset:1024 lds
    buffer_load_dwordx4 v19, s[12:15], s79 offen offset:2048 lds
    s_add_u32 m0, s77, 14336
    s_and_b32 s73, s73, 7
    buffer_load_dwordx4 v18, s[12:15], s79 offen offset:2048 lds
    buffer_load_dwordx4 v19, s[12:15], s79 offen offset:3072 lds
    s_waitcnt vmcnt(8)
    s_barrier
    s_lshl_b32 s78, s72, 7
    s_mov_b32 m0, s76
    s_add_u32 s78, s78, s74
    buffer_load_dwordx4 v16, s[8:11], s78 offen lds
    buffer_load_dwordx4 v17, s[8:11], s78 offen offset:1024 lds
    s_add_u32 s76, s76, 8192
    s_add_u32 s72, s72, 1
    s_and_b32 s72, s72, 7
    s_add_u32 s77, s77, 24576
    s_cmp_eq_u32 s77, s81
    s_cmov_b32 s77, s80
    s_mul_i32 s79, s73, 196608
    s_mov_b32 m0, s77
    s_add_u32 s79, s79, s75
    buffer_load_dwordx4 v18, s[12:15], s79 offen offset:0 lds
    buffer_load_dwordx4 v19, s[12:15], s79 offen offset:1024 lds
    s_add_u32 m0, s77, 7168
    s_add_u32 s73, s73, 1
    buffer_load_dwordx4 v18, s[12:15], s79 offen offset:1024 lds
    buffer_load_dwordx4 v19, s[12:15], s79 offen offset:2048 lds
    s_add_u32 m0, s77, 14336
    s_and_b32 s73, s73, 7
    buffer_load_dwordx4 v18, s[12:15], s79 offen offset:2048 lds
    buffer_load_dwordx4 v19, s[12:15], s79 offen offset:3072 lds
    s_waitcnt vmcnt(8)
    s_barrier
    s_lshl_b32 s78, s72, 7
    s_mov_b32 m0, s76
    s_add_u32 s78, s78, s74
    buffer_load_dwordx4 v16, s[8:11], s78 offen lds
    buffer_load_dwordx4 v17, s[8:11], s78 offen offset:1024 lds
    s_add_u32 s76, s76, 8192
    s_add_u32 s72, s72, 1
    s_and_b32 s72, s72, 7
    s_add_u32 s77, s77, 24576
    s_cmp_eq_u32 s77, s81
    s_cmov_b32 s77, s80
    s_mul_i32 s79, s73, 196608
    s_mov_b32 m0, s77
    s_add_u32 s79, s79, s75
    buffer_load_dwordx4 v18, s[12:15], s79 offen offset:0 lds
    buffer_load_dwordx4 v19, s[12:15], s79 offen offset:1024 lds
    s_add_u32 m0, s77, 7168
    s_add_u32 s73, s73, 1
    buffer_load_dwordx4 v18, s[12:15], s79 offen offset:1024 lds
    buffer_load_dwordx4 v19, s[12:15], s79 offen offset:2048 lds
    s_add_u32 m0, s77, 14336
    s_and_b32 s73, s73, 7
    buffer_load_dwordx4 v18, s[12:15], s79 offen offset:2048 lds
    buffer_load_dwordx4 v19, s[12:15], s79 offen offset:3072 lds
    s_lshl_b32 s75, s100, 5
    s_and_b32 s78, s3, 1
    s_mul_i32 s77, s78, 44032
    s_add_u32 s75, s75, s77
    s_mul_i32 s77, s78, 6144
    s_lshr_b32 s78, s3, 1
    s_mul_i32 s78, s78, 3072
    s_add_u32 s77, s77, s78
    s_xor_b32 s74, s74, 0x80000
    s_lshl_b32 s80, s3, 11
    s_waitcnt vmcnt(8)
    s_barrier
    s_add_u32 s73, s46, 7
    s_and_b32 s73, s73, 3
    s_or_b32 s73, s73, 0
    s_mul_i32 s79, s73, 176128
    s_add_u32 m0, s77, 65536
    s_add_u32 s79, s79, s75
    buffer_load_dwordx4 v20, s[24:27], s79 offen offset:0 lds
    s_add_u32 m0, s77, 66496
    s_nop 0
    buffer_load_dwordx4 v20, s[24:27], s79 offen offset:64 lds
    s_add_u32 m0, s77, 67456
    s_nop 0
    buffer_load_dwordx4 v20, s[24:27], s79 offen offset:128 lds
    s_add_u32 m0, s77, 77824
    s_add_u32 s79, s79, 88064
    buffer_load_dwordx4 v20, s[24:27], s79 offen offset:0 lds
    s_add_u32 m0, s77, 78784
    s_nop 0
    buffer_load_dwordx4 v20, s[24:27], s79 offen offset:64 lds
    s_add_u32 m0, s77, 79744
    s_nop 0
    buffer_load_dwordx4 v20, s[24:27], s79 offen offset:128 lds
    s_add_u32 s76, s80, 106496
    s_add_u32 s72, s46, 7
    s_and_b32 s72, s72, 3
    s_or_b32 s72, s72, 0
    s_lshl_b32 s78, s72, 7
    s_mov_b32 m0, s76
    s_add_u32 s78, s78, s74
    buffer_load_dwordx4 v16, s[8:11], s78 offen lds
    buffer_load_dwordx4 v17, s[8:11], s78 offen offset:1024 lds
    s_add_u32 s76, s76, 8192
    s_add_u32 s72, s72, 1
    s_and_b32 s72, s72, 7
    s_waitcnt vmcnt(8)
    s_barrier
    s_waitcnt lgkmcnt(0)
    s_add_u32 s70, s70, 1
    s_setprio 2
    s_cmp_eq_u32 s66, 0
    s_cbranch_scc1 L_gt2
L_gtr2:
    s_add_u32 s76, s80, 90112
    s_add_u32 s72, s46, 8
    s_and_b32 s72, s72, 3
    s_or_b32 s72, s72, 0
    s_lshl_b32 s78, s72, 7
    s_mov_b32 m0, s76
    s_add_u32 s78, s78, s74
    buffer_load_dwordx4 v16, s[8:11], s78 offen lds
    buffer_load_dwordx4 v17, s[8:11], s78 offen offset:1024 lds
    s_add_u32 s76, s76, 8192
    s_add_u32 s72, s72, 1
    s_and_b32 s72, s72, 7
    s_add_u32 s73, s46, 8
    s_and_b32 s73, s73, 3
    s_or_b32 s73, s73, 0
    s_mul_i32 s79, s73, 176128
    s_add_u32 m0, s77, 114688
    s_add_u32 s79, s79, s75
    buffer_load_dwordx4 v20, s[24:27], s79 offen offset:0 lds
    s_add_u32 m0, s77, 115648
    s_nop 0
    buffer_load_dwordx4 v20, s[24:27], s79 offen offset:64 lds
    s_add_u32 m0, s77, 116608
    s_nop 0
    buffer_load_dwordx4 v20, s[24:27], s79 offen offset:128 lds
    s_add_u32 m0, s77, 126976
    s_add_u32 s79, s79, 88064
    buffer_load_dwordx4 v20, s[24:27], s79 offen offset:0 lds
    s_add_u32 m0, s77, 127936
    s_nop 0
    buffer_load_dwordx4 v20, s[24:27], s79 offen offset:64 lds
    s_add_u32 m0, s77, 128896
    s_nop 0
    buffer_load_dwordx4 v20, s[24:27], s79 offen offset:128 lds
    s_cmp_eq_u32 s66, 0
    s_cbranch_scc1 L_gt3
L_gtr3:
    s_waitcnt vmcnt(8)
    s_barrier
    s_cmp_eq_u32 s66, 0
    s_cbranch_scc1 L_gt4
L_gtr4:
    s_add_u32 s76, s80, 98304
    s_add_u32 s72, s46, 9
    s_and_b32 s72, s72, 3
    s_or_b32 s72, s72, 0
    s_lshl_b32 s78, s72, 7
    s_mov_b32 m0, s76
    s_add_u32 s78, s78, s74
    buffer_load_dwordx4 v16, s[8:11], s78 offen lds
    buffer_load_dwordx4 v17, s[8:11], s78 offen offset:1024 lds
    s_add_u32 s76, s76, 8192
    s_add_u32 s72, s72, 1
    s_and_b32 s72, s72, 7
    s_add_u32 s73, s46, 9
    s_and_b32 s73, s73, 3
    s_or_b32 s73, s73, 0
    s_mul_i32 s79, s73, 176128
    s_add_u32 m0, s77, 139264
    s_add_u32 s79, s79, s75
    buffer_load_dwordx4 v20, s[24:27], s79 offen offset:0 lds
    s_add_u32 m0, s77, 140224
    s_nop 0
    buffer_load_dwordx4 v20, s[24:27], s79 offen offset:64 lds
    s_add_u32 m0, s77, 141184
    s_nop 0
    buffer_load_dwordx4 v20, s[24:27], s79 offen offset:128 lds
    s_add_u32 m0, s77, 151552
    s_add_u32 s79, s79, 88064
    buffer_load_dwordx4 v20, s[24:27], s79 offen offset:0 lds
    s_add_u32 m0, s77, 152512
    s_nop 0
    buffer_load_dwordx4 v20, s[24:27], s79 offen offset:64 lds
    s_add_u32 m0, s77, 153472
    s_nop 0
    buffer_load_dwordx4 v20, s[24:27], s79 offen offset:128 lds
    s_cmp_eq_u32 s66, 0
    s_cbranch_scc1 L_gt5
L_gtr5:
    s_waitcnt vmcnt(8)
    s_barrier
    s_cmp_eq_u32 s66, 0
    s_cbranch_scc1 L_gt6
L_gtr6:
    s_add_u32 s76, s80, 106496
    s_add_u32 s72, s46, 10
    s_and_b32 s72, s72, 3
    s_or_b32 s72, s72, 0
    s_lshl_b32 s78, s72, 7
    s_mov_b32 m0, s76
    s_add_u32 s78, s78, s74
    buffer_load_dwordx4 v16, s[8:11], s78 offen lds
    buffer_load_dwordx4 v17, s[8:11], s78 offen offset:1024 lds
    s_add_u32 s76, s76, 8192
    s_add_u32 s72, s72, 1
    s_and_b32 s72, s72, 7
    s_add_u32 s73, s46, 10
    s_and_b32 s73, s73, 3
    s_or_b32 s73, s73, 0
    s_mul_i32 s79, s73, 176128
    s_add_u32 m0, s77, 65536
    s_add_u32 s79, s79, s75
    buffer_load_dwordx4 v20, s[24:27], s79 offen offset:0 lds
    s_add_u32 m0, s77, 66496
    s_nop 0
    buffer_load_dwordx4 v20, s[24:27], s79 offen offset:64 lds
    s_add_u32 m0, s77, 67456
    s_nop 0
    buffer_load_dwordx4 v20, s[24:27], s79 offen offset:128 lds
    s_add_u32 m0, s77, 77824
    s_add_u32 s79, s79, 88064
    buffer_load_dwordx4 v20, s[24:27], s79 offen offset:0 lds
    s_add_u32 m0, s77, 78784
    s_nop 0
    buffer_load_dwordx4 v20, s[24:27], s79 offen offset:64 lds
    s_add_u32 m0, s77, 79744
    s_nop 0
    buffer_load_dwordx4 v20, s[24:27], s79 offen offset:128 lds
    s_cmp_eq_u32 s66, 0
    s_cbranch_scc1 L_gt7
L_gtr7:
    s_waitcnt vmcnt(8)
    s_barrier
    s_cmp_eq_u32 s66, 0
    s_cbranch_scc1 L_gt8
L_gtr8:
    s_add_u32 s76, s80, 90112
    s_add_u32 s72, s46, 11
    s_and_b32 s72, s72, 3
    s_or_b32 s72, s72, 4
    s_lshl_b32 s78, s72, 7
    s_mov_b32 m0, s76
    s_add_u32 s78, s78, s74
    buffer_load_dwordx4 v16, s[8:11], s78 offen lds
    buffer_load_dwordx4 v17, s[8:11], s78 offen offset:1024 lds
    s_add_u32 s76, s76, 8192
    s_add_u32 s72, s72, 1
    s_and_b32 s72, s72, 7
    s_add_u32 s73, s46, 11
    s_and_b32 s73, s73, 3
    s_or_b32 s73, s73, 4
    s_mul_i32 s79, s73, 176128
    s_add_u32 m0, s77, 114688
    s_add_u32 s79, s79, s75
    buffer_load_dwordx4 v20, s[24:27], s79 offen offset:0 lds
    s_add_u32 m0, s77, 115648
    s_nop 0
    buffer_load_dwordx4 v20, s[24:27], s79 offen offset:64 lds
    s_add_u32 m0, s77, 116608
    s_nop 0
    buffer_load_dwordx4 v20, s[24:27], s79 offen offset:128 lds
    s_add_u32 m0, s77, 126976
    s_add_u32 s79, s79, 88064
    buffer_load_dwordx4 v20, s[24:27], s79 offen offset:0 lds
    s_add_u32 m0, s77, 127936
    s_nop 0
    buffer_load_dwordx4 v20, s[24:27], s79 offen offset:64 lds
    s_add_u32 m0, s77, 128896
    s_nop 0
    buffer_load_dwordx4 v20, s[24:27], s79 offen offset:128 lds
    s_cmp_eq_u32 s66, 0
    s_cbranch_scc1 L_gt9
L_gtr9:
    s_waitcnt vmcnt(8)
    s_barrier
    s_add_u32 s76, s80, 98304
    s_add_u32 s72, s46, 12
    s_and_b32 s72, s72, 3
    s_or_b32 s72, s72, 4
    s_lshl_b32 s78, s72, 7
    s_mov_b32 m0, s76
    s_add_u32 s78, s78, s74
    buffer_load_dwordx4 v16, s[8:11], s78 offen lds
    buffer_load_dwordx4 v17, s[8:11], s78 offen offset:1024 lds
    s_add_u32 s76, s76, 8192
    s_add_u32 s72, s72, 1
    s_and_b32 s72, s72, 7
    s_add_u32 s73, s46, 12
    s_and_b32 s73, s73, 3
    s_or_b32 s73, s73, 4
    s_mul_i32 s79, s73, 176128
    s_add_u32 m0, s77, 139264
    s_add_u32 s79, s79, s75
    buffer_load_dwordx4 v20, s[24:27], s79 offen offset:0 lds
    s_add_u32 m0, s77, 140224
    s_nop 0
    buffer_load_dwordx4 v20, s[24:27], s79 offen offset:64 lds
    s_add_u32 m0, s77, 141184
    s_nop 0
    buffer_load_dwordx4 v20, s[24:27], s79 offen offset:128 lds
    s_add_u32 m0, s77, 151552
    s_add_u32 s79, s79, 88064
    buffer_load_dwordx4 v20, s[24:27], s79 offen offset:0 lds
    s_add_u32 m0, s77, 152512
    s_nop 0
    buffer_load_dwordx4 v20, s[24:27], s79 offen offset:64 lds
    s_add_u32 m0, s77, 153472
    s_nop 0
    buffer_load_dwordx4 v20, s[24:27], s79 offen offset:128 lds
    s_cmp_eq_u32 s66, 0
    s_cbranch_scc1 L_gt11
L_gtr11:
    s_waitcnt vmcnt(8)
    s_barrier
    s_cmp_eq_u32 s66, 0
    s_cbranch_scc1 L_gt12
L_gtr12:
    s_add_u32 s76, s80, 106496
    s_add_u32 s72, s46, 13
    s_and_b32 s72, s72, 3
    s_or_b32 s72, s72, 4
    s_lshl_b32 s78, s72, 7
    s_mov_b32 m0, s76
    s_add_u32 s78, s78, s74
    buffer_load_dwordx4 v16, s[8:11], s78 offen lds
    buffer_load_dwordx4 v17, s[8:11], s78 offen offset:1024 lds
    s_add_u32 s76, s76, 8192
    s_add_u32 s72, s72, 1
    s_and_b32 s72, s72, 7
    s_add_u32 s73, s46, 13
    s_and_b32 s73, s73, 3
    s_or_b32 s73, s73, 4
    s_mul_i32 s79, s73, 176128
    s_add_u32 m0, s77, 65536
    s_add_u32 s79, s79, s75
    buffer_load_dwordx4 v20, s[24:27], s79 offen offset:0 lds
    s_add_u32 m0, s77, 66496
    s_nop 0
    buffer_load_dwordx4 v20, s[24:27], s79 offen offset:64 lds
    s_add_u32 m0, s77, 67456
    s_nop 0
    buffer_load_dwordx4 v20, s[24:27], s79 offen offset:128 lds
    s_add_u32 m0, s77, 77824
    s_add_u32 s79, s79, 88064
    buffer_load_dwordx4 v20, s[24:27], s79 offen offset:0 lds
    s_add_u32 m0, s77, 78784
    s_nop 0
    buffer_load_dwordx4 v20, s[24:27], s79 offen offset:64 lds
    s_add_u32 m0, s77, 79744
    s_nop 0
    buffer_load_dwordx4 v20, s[24:27], s79 offen offset:128 lds
    s_waitcnt vmcnt(8)
    s_barrier
    s_cmp_eq_u32 s66, 0
    s_cbranch_scc1 L_gt14
L_gtr14:
    s_add_u32 s76, s80, 90112
    s_add_u32 s72, s46, 14
    s_and_b32 s72, s72, 3
    s_or_b32 s72, s72, 4
    s_lshl_b32 s78, s72, 7
    s_mov_b32 m0, s76
    s_add_u32 s78, s78, s74
    buffer_load_dwordx4 v16, s[8:11], s78 offen lds
    buffer_load_dwordx4 v17, s[8:11], s78 offen offset:1024 lds
    s_add_u32 s76, s76, 8192
    s_add_u32 s72, s72, 1
    s_and_b32 s72, s72, 7
    s_add_u32 s73, s46, 14
    s_and_b32 s73, s73, 3
    s_or_b32 s73, s73, 4
    s_mul_i32 s79, s73, 176128
    s_add_u32 m0, s77, 114688
    s_add_u32 s79, s79, s75
    buffer_load_dwordx4 v20, s[24:27], s79 offen offset:0 lds
    s_add_u32 m0, s77, 115648
    s_nop 0
    buffer_load_dwordx4 v20, s[24:27], s79 offen offset:64 lds
    s_add_u32 m0, s77, 116608
    s_nop 0
    buffer_load_dwordx4 v20, s[24:27], s79 offen offset:128 lds
    s_add_u32 m0, s77, 126976
    s_add_u32 s79, s79, 88064
    buffer_load_dwordx4 v20, s[24:27], s79 offen offset:0 lds
    s_add_u32 m0, s77, 127936
    s_nop 0
    buffer_load_dwordx4 v20, s[24:27], s79 offen offset:64 lds
    s_add_u32 m0, s77, 128896
    s_nop 0
    buffer_load_dwordx4 v20, s[24:27], s79 offen offset:128 lds
    s_waitcnt vmcnt(8)
    s_barrier
    s_lshr_b32 s76, s6, 2
    s_lshl_b32 s76, s76, 12
    s_add_u32 s76, s76, 0xd00000
    s_mov_b32 exec_hi, 0
    buffer_load_dword v6, v7, s[16:19], s76 offen sc1
    s_lshl_b32 s81, s3, 10
    s_mul_i32 s80, s3, 1040
    s_add_u32 s80, s80, 65536
    s_lshl_b32 s79, s6, 16
    s_add_u32 s79, s79, s81
    s_add_u32 s79, s79, 0x200000
    s_mov_b32 s74, 0
    s_waitcnt vmcnt(0)
    v_cmp_ne_u32 vcc, s70, v6
    s_cbranch_vccnz L_g_p0r
L_g_p0k:
    s_mov_b64 exec, -1
    s_barrier
    s_mov_b32 m0, s81
    s_add_u32 s76, s79, 0x200000
    buffer_load_dwordx4 v2, s[16:19], s79 offen sc1 lds
    s_mov_b32 m0, s80
    s_add_u32 s77, s79, 0x8000
    buffer_load_dwordx4 v2, s[16:19], s76 offen sc1 lds
    s_add_u32 m0, s81, 0x8000
    s_add_u32 s76, s76, 0x8000
    buffer_load_dwordx4 v2, s[16:19], s77 offen sc1 lds
    s_add_u32 m0, s80, 33280
    s_add_u32 s79, s79, 4096
    buffer_load_dwordx4 v2, s[16:19], s76 offen sc1 lds
    s_add_u32 s81, s81, 4096
    s_add_u32 s80, s80, 4160
    s_mov_b32 m0, s81
    s_add_u32 s76, s79, 0x200000
    buffer_load_dwordx4 v2, s[16:19], s79 offen sc1 lds
    s_mov_b32 m0, s80
    s_add_u32 s77, s79, 0x8000
    buffer_load_dwordx4 v2, s[16:19], s76 offen sc1 lds
    s_add_u32 m0, s81, 0x8000
    s_add_u32 s76, s76, 0x8000
    buffer_load_dwordx4 v2, s[16:19], s77 offen sc1 lds
    s_add_u32 m0, s80, 33280
    s_add_u32 s79, s79, 4096
    buffer_load_dwordx4 v2, s[16:19], s76 offen sc1 lds
    s_add_u32 s81, s81, 4096
    s_add_u32 s80, s80, 4160
    s_barrier
L_ld_done:
    s_setprio 3
    s_getpc_b64 s[44:45]
    s_mov_b32 s46, 64
    s_mov_b32 s47, 0x20000
    s_lshl_b32 s54, s3, 2
    s_add_u32 s54, s54, 162816
    s_mov_b32 m0, s81
    s_add_u32 s76, s79, 0x200000
    buffer_load_dwordx4 v2, s[16:19], s79 offen sc1 lds
    s_mov_b32 m0, s80
    s_add_u32 s77, s79, 0x8000
    buffer_load_dwordx4 v2, s[16:19], s76 offen sc1 lds
    s_add_u32 m0, s81, 0x8000
    s_add_u32 s76, s76, 0x8000
    buffer_load_dwordx4 v2, s[16:19], s77 offen sc1 lds
    s_add_u32 m0, s80, 33280
    s_add_u32 s79, s79, 4096
    buffer_load_dwordx4 v2, s[16:19], s76 offen sc1 lds
    s_add_u32 s81, s81, 4096
    s_add_u32 s80, s80, 4160
    s_mov_b32 m0, s81
    s_add_u32 s76, s79, 0x200000
    buffer_load_dwordx4 v2, s[16:19], s79 offen sc1 lds
    s_mov_b32 m0, s80
    s_add_u32 s77, s79, 0x8000
    buffer_load_dwordx4 v2, s[16:19], s76 offen sc1 lds
    s_add_u32 m0, s81, 0x8000
    s_add_u32 s76, s76, 0x8000
    buffer_load_dwordx4 v2, s[16:19], s77 offen sc1 lds
    s_add_u32 m0, s80, 33280
    s_add_u32 s79, s79, 4096
    buffer_load_dwordx4 v2, s[16:19], s76 offen sc1 lds
    s_add_u32 s81, s81, 4096
    s_add_u32 s80, s80, 4160
    s_waitcnt vmcnt(8)
    s_barrier
L_g_kvl:
    s_mov_b32 m0, s81
    s_add_u32 s76, s79, 0x200000
    buffer_load_dwordx4 v2, s[16:19], s79 offen sc1 lds
    s_mov_b32 m0, s80
    s_add_u32 s77, s79, 0x8000
    buffer_load_dwordx4 v2, s[16:19], s76 offen sc1 lds
    s_add_u32 m0, s81, 0x8000
    s_add_u32 s76, s76, 0x8000
    buffer_load_dwordx4 v2, s[16:19], s77 offen sc1 lds
    s_add_u32 m0, s80, 33280
    s_add_u32 s79, s79, 4096
    buffer_load_dwordx4 v2, s[16:19], s76 offen sc1 lds
    s_add_u32 s81, s81, 4096
    s_add_u32 s80, s80, 4160
    s_add_u32 s74, s74, 1
    s_cmp_lt_u32 s74, 4
    s_cbranch_scc1 L_g_kvl
    s_add_u32 m0, s54, 80
    s_mov_b64 exec, 1
    buffer_load_dword off, s[44:47], 0 lds
    s_mov_b64 exec, -1
    s_and_b32 s78, s3, 1
    s_lshl_b32 s78, s78, 10
    v_add_u32 v2, s78, v2
    v_xor_b32 v5, 1024, v2
    s_mul_i32 s78, s71, 11
    s_lshr_b32 s78, s78, 1
    s_lshl_b32 s48, s78, 14
    s_add_u32 s48, s48, s63
    s_lshl_b32 s49, s78, 16
    s_add_u32 s49, s49, s60
    s_add_u32 s50, s63, 360448
    s_add_u32 s51, s60, 1441792
    s_add_u32 m0, s64, 2048
    s_add_u32 s79, s62, 49152
    buffer_load_dwordx4 v8, s[32:35], s79 offen lds
    s_add_u32 m0, s64, 3072
    s_add_u32 s79, s62, 57344
    buffer_load_dwordx4 v8, s[32:35], s79 offen lds
    s_add_u32 m0, s64, 4096
    s_add_u32 s79, s62, 65536
    buffer_load_dwordx4 v8, s[32:35], s79 offen lds
    s_add_u32 m0, s64, 5120
    s_add_u32 s79, s62, 73728
    buffer_load_dwordx4 v8, s[32:35], s79 offen lds
    s_add_u32 m0, s64, 0
    s_add_u32 s79, s62, 81920
    buffer_load_dwordx4 v8, s[32:35], s79 offen lds
    s_add_u32 m0, s64, 1024
    s_add_u32 s79, s62, 90112
    buffer_load_dwordx4 v8, s[32:35], s79 offen lds
    s_waitcnt vmcnt(4)
    ds_read_b64_tr_b16 v[64:65], v9 offset:2048
    ds_read_b64_tr_b16 v[66:67], v9 offset:3072
    ds_read_b64_tr_b16 v[68:69], v9 offset:2560
    ds_read_b64_tr_b16 v[70:71], v9 offset:3584
    s_waitcnt lgkmcnt(0)
    s_add_u32 m0, s64, 2048
    s_add_u32 s79, s62, 98304
    buffer_load_dwordx4 v8, s[32:35], s79 offen lds
    s_add_u32 m0, s64, 3072
    s_add_u32 s79, s62, 106496
    buffer_load_dwordx4 v8, s[32:35], s79 offen lds
    s_waitcnt vmcnt(4)
    ds_read_b64_tr_b16 v[72:73], v9 offset:4096
    ds_read_b64_tr_b16 v[74:75], v9 offset:5120
    ds_read_b64_tr_b16 v[76:77], v9 offset:4608
    ds_read_b64_tr_b16 v[78:79], v9 offset:5632
    s_waitcnt lgkmcnt(0)
    s_add_u32 m0, s64, 4096
    s_add_u32 s79, s62, 114688
    buffer_load_dwordx4 v8, s[32:35], s79 offen lds
    s_add_u32 m0, s64, 5120
    s_add_u32 s79, s62, 122880
    buffer_load_dwordx4 v8, s[32:35], s79 offen lds
    s_waitcnt vmcnt(4)
    ds_read_b64_tr_b16 v[80:81], v9 offset:0
    ds_read_b64_tr_b16 v[82:83], v9 offset:1024
    ds_read_b64_tr_b16 v[84:85], v9 offset:512
    ds_read_b64_tr_b16 v[86:87], v9 offset:1536
    s_waitcnt lgkmcnt(0)
    s_add_u32 m0, s64, 0
    s_nop 0
    buffer_load_dwordx4 v8, s[28:31], s48 offen lds
    s_add_u32 s48, s48, 8192
    s_add_u32 m0, s64, 1024
    s_nop 0
    buffer_load_dwordx4 v8, s[28:31], s48 offen lds
    s_add_u32 s48, s48, 8192
    s_cmp_eq_u32 s48, s50
    s_cmov_b32 s48, s63
    s_waitcnt vmcnt(4)
    ds_read_b64_tr_b16 v[88:89], v9 offset:2048
    ds_read_b64_tr_b16 v[90:91], v9 offset:3072
    ds_read_b64_tr_b16 v[92:93], v9 offset:2560
    ds_read_b64_tr_b16 v[94:95], v9 offset:3584
    s_waitcnt lgkmcnt(0)
    s_add_u32 m0, s64, 2048
    s_nop 0
    buffer_load_dwordx4 v8, s[28:31], s48 offen lds
    s_add_u32 s48, s48, 8192
    s_add_u32 m0, s64, 3072
    s_nop 0
    buffer_load_dwordx4 v8, s[28:31], s48 offen lds
    s_add_u32 s48, s48, 8192
    s_cmp_eq_u32 s48, s50
    s_cmov_b32 s48, s63
    s_waitcnt vmcnt(4)
    ds_read_b64_tr_b16 v[96:97], v9 offset:4096
    ds_read_b64_tr_b16 v[98:99], v9 offset:5120
    ds_read_b64_tr_b16 v[100:101], v9 offset:4608
    ds_read_b64_tr_b16 v[102:103], v9 offset:5632
    s_waitcnt lgkmcnt(0)
    s_add_u32 m0, s64, 4096
    s_nop 0
    buffer_load_dwordx4 v8, s[28:31], s48 offen lds
    s_add_u32 s48, s48, 8192
    s_add_u32 m0, s64, 5120
    s_nop 0
    buffer_load_dwordx4 v8, s[28:31], s48 offen lds
    s_add_u32 s48, s48, 8192
    s_cmp_eq_u32 s48, s50
    s_cmov_b32 s48, s63
    s_lshl_b32 s75, s3, 19
    s_lshl_b32 s80, s6, 11
    s_add_u32 s75, s75, s80
    s_add_u32 s75, s75, 0x600000
    s_mov_b64 exec, 0x3ffff
L_gp_4:
    buffer_load_dword v6, v61, s[16:19], 0 offen sc1
    s_waitcnt vmcnt(0)
    v_cmp_ne_u32 vcc, s70, v6
    s_cbranch_vccnz L_rt_6
L_gpd_5:
    s_mov_b64 exec, -1
    s_lshl_b32 s78, s3, 2
    s_cmp_eq_u32 s3, 1
    s_cmov_b32 s78, 3
    s_cselect_b32 s76, 24, 16
    s_lshl4_add_u32 s78, s6, s78
    s_lshl_b32 s78, s78, 9
    s_add_u32 s78, s78, 0xd88000
    s_bfm_b64 exec, s76, 0
L_gp_7:
    buffer_load_dword v6, v7, s[16:19], s78 offen sc1
    s_waitcnt vmcnt(0)
    v_cmp_ne_u32 vcc, s70, v6
    s_cbranch_vccnz L_rt_9
L_gpd_8:
    s_mov_b64 exec, -1
    s_and_b32 s79, s3, 1
    s_lshl1_add_u32 s79, s6, s79
    s_lshl_b32 s79, s79, 7
    s_add_u32 s79, s79, 0xc00000
    s_xor_b32 s78, s79, 128
    buffer_load_dword v10, v13, s[16:19], s79 offen sc1
    buffer_load_dword v11, v13, s[16:19], s78 offen sc1
    buffer_load_dwordx4 v[28:31], v2, s[20:23], s49 offen sc1
    buffer_load_dwordx4 v[32:35], v5, s[20:23], s49 offen sc1
    s_add_u32 s49, s49, 0x10000
    s_cmp_eq_u32 s49, s51
    s_cmov_b32 s49, s60
    buffer_load_dwordx4 v[36:39], v2, s[20:23], s49 offen sc1
    buffer_load_dwordx4 v[40:43], v5, s[20:23], s49 offen sc1
    s_add_u32 s49, s49, 0x10000
    s_cmp_eq_u32 s49, s51
    s_cmov_b32 s49, s60
    buffer_load_dwordx4 v[44:47], v2, s[20:23], s49 offen sc1
    buffer_load_dwordx4 v[48:51], v5, s[20:23], s49 offen sc1
    s_add_u32 s49, s49, 0x10000
    s_cmp_eq_u32 s49, s51
    s_cmov_b32 s49, s60
    s_mul_i32 s79, s7, 0x30000
    s_add_u32 s79, s79, s60
    s_mov_b32 exec_hi, 0xffff
    buffer_load_dword v62, v60, s[20:23], s79 offen sc1
    s_mov_b64 exec, -1
    ds_read_b64_tr_b16 v[12:13], v63 offset:0
    ds_read_b64_tr_b16 v[14:15], v63 offset:256
    ds_read_b64_tr_b16 v[16:17], v63 offset:512
    ds_read_b64_tr_b16 v[18:19], v63 offset:768
    s_setprio 0
    s_waitcnt vmcnt(5)
    s_waitcnt lgkmcnt(0)
    ds_read_b64_tr_b16 v[20:21], v63 offset:2048
    ds_read_b64_tr_b16 v[22:23], v63 offset:2304
    ds_read_b64_tr_b16 v[24:25], v63 offset:2560
    ds_read_b64_tr_b16 v[26:27], v63 offset:2816
    v_mfma_f32_32x32x16_bf16 v[104:119], v[12:15], v[28:31], 0
    s_add_u32 m0, s64, 0
    s_nop 0
    buffer_load_dwordx4 v8, s[28:31], s48 offen lds
    s_add_u32 s48, s48, 8192
    v_mfma_f32_32x32x16_bf16 v[120:135], v[12:15], v[32:35], 0
    s_add_u32 m0, s64, 1024
    s_nop 0
    buffer_load_dwordx4 v8, s[28:31], s48 offen lds
    s_add_u32 s48, s48, 8192
    s_cmp_eq_u32 s48, s50
    s_cmov_b32 s48, s63
    v_mfma_f32_32x32x16_bf16 v[136:151], v[16:19], v[28:31], 0
    buffer_load_dwordx4 v[52:55], v2, s[20:23], s49 offen sc1
    v_mfma_f32_32x32x16_bf16 v[152:167], v[16:19], v[32:35], 0
    buffer_load_dwordx4 v[56:59], v5, s[20:23], s49 offen sc1
    s_add_u32 s49, s49, 0x10000
    s_cmp_eq_u32 s49, s51
    s_cmov_b32 s49, s60
    s_waitcnt vmcnt(7)
    s_waitcnt lgkmcnt(0)
    ds_read_b64_tr_b16 v[12:13], v63 offset:4096
    ds_read_b64_tr_b16 v[14:15], v63 offset:4352
    ds_read_b64_tr_b16 v[16:17], v63 offset:4608
    ds_read_b64_tr_b16 v[18:19], v63 offset:4864
    v_mfma_f32_32x32x16_bf16 v[104:119], v[20:23], v[36:39], v[104:119]
    s_add_u32 m0, s64, 2048
    s_nop 0
    buffer_load_dwordx4 v8, s[28:31], s48 offen lds
    s_add_u32 s48, s48, 8192
    v_mfma_f32_32x32x16_bf16 v[120:135], v[20:23], v[40:43], v[120:135]
    s_add_u32 m0, s64, 3072
    s_nop 0
    buffer_load_dwordx4 v8, s[28:31], s48 offen lds
    s_add_u32 s48, s48, 8192
    s_cmp_eq_u32 s48, s50
    s_cmov_b32 s48, s63
    v_mfma_f32_32x32x16_bf16 v[136:151], v[24:27], v[36:39], v[136:151]
    buffer_load_dwordx4 v[28:31], v2, s[20:23], s49 offen sc1
    v_mfma_f32_32x32x16_bf16 v[152:167], v[24:27], v[40:43], v[152:167]
    buffer_load_dwordx4 v[32:35], v5, s[20:23], s49 offen sc1
    s_add_u32 s49, s49, 0x10000
    s_cmp_eq_u32 s49, s51
    s_cmov_b32 s49, s60
    s_waitcnt vmcnt(6)
    s_waitcnt lgkmcnt(0)
    ds_read_b64_tr_b16 v[20:21], v63 offset:0
    ds_read_b64_tr_b16 v[22:23], v63 offset:256
    ds_read_b64_tr_b16 v[24:25], v63 offset:512
    ds_read_b64_tr_b16 v[26:27], v63 offset:768
    v_mfma_f32_32x32x16_bf16 v[104:119], v[12:15], v[44:47], v[104:119]
    s_add_u32 m0, s64, 4096
    s_nop 0
    buffer_load_dwordx4 v8, s[28:31], s48 offen lds
    s_add_u32 s48, s48, 8192
    v_mfma_f32_32x32x16_bf16 v[120:135], v[12:15], v[48:51], v[120:135]
    s_add_u32 m0, s64, 5120
    s_nop 0
    buffer_load_dwordx4 v8, s[28:31], s48 offen lds
    s_add_u32 s48, s48, 8192
    s_cmp_eq_u32 s48, s50
    s_cmov_b32 s48, s63
    v_mfma_f32_32x32x16_bf16 v[136:151], v[16:19], v[44:47], v[136:151]
    buffer_load_dwordx4 v[36:39], v2, s[20:23], s49 offen sc1
    v_mfma_f32_32x32x16_bf16 v[152:167], v[16:19], v[48:51], v[152:167]
    buffer_load_dwordx4 v[40:43], v5, s[20:23], s49 offen sc1
    s_add_u32 s49, s49, 0x10000
    s_cmp_eq_u32 s49, s51
    s_cmov_b32 s49, s60
    s_waitcnt vmcnt(6)
    s_waitcnt lgkmcnt(0)
    ds_read_b64_tr_b16 v[12:13], v63 offset:2048
    ds_read_b64_tr_b16 v[14:15], v63 offset:2304
    ds_read_b64_tr_b16 v[16:17], v63 offset:2560
    ds_read_b64_tr_b16 v[18:19], v63 offset:2816
    v_mfma_f32_32x32x16_bf16 v[104:119], v[20:23], v[52:55], v[104:119]
    s_add_u32 m0, s64, 0
    s_nop 0
    buffer_load_dwordx4 v8, s[28:31], s48 offen lds
    s_add_u32 s48, s48, 8192
    v_mfma_f32_32x32x16_bf16 v[120:135], v[20:23], v[56:59], v[120:135]
    s_add_u32 m0, s64, 1024
    s_nop 0
    buffer_load_dwordx4 v8, s[28:31], s48 offen lds
    s_add_u32 s48, s48, 8192
    s_cmp_eq_u32 s48, s50
    s_cmov_b32 s48, s63
    v_mfma_f32_32x32x16_bf16 v[136:151], v[24:27], v[52:55], v[136:151]
    buffer_load_dwordx4 v[44:47], v2, s[20:23], s49 offen sc1
    v_mfma_f32_32x32x16_bf16 v[152:167], v[24:27], v[56:59], v[152:167]
    buffer_load_dwordx4 v[48:51], v5, s[20:23], s49 offen sc1
    s_add_u32 s49, s49, 0x10000
    s_cmp_eq_u32 s49, s51
    s_cmov_b32 s49, s60
    s_waitcnt vmcnt(6)
    s_waitcnt lgkmcnt(0)
    ds_read_b64_tr_b16 v[20:21], v63 offset:4096
    ds_read_b64_tr_b16 v[22:23], v63 offset:4352
    ds_read_b64_tr_b16 v[24:25], v63 offset:4608
    ds_read_b64_tr_b16 v[26:27], v63 offset:4864
    v_mfma_f32_32x32x16_bf16 v[104:119], v[12:15], v[28:31], v[104:119]
    s_add_u32 m0, s64, 2048
    s_nop 0
    buffer_load_dwordx4 v8, s[28:31], s48 offen lds
    s_add_u32 s48, s48, 8192
    v_mfma_f32_32x32x16_bf16 v[120:135], v[12:15], v[32:35], v[120:135]
    s_add_u32 m0, s64, 3072
    s_nop 0
    buffer_load_dwordx4 v8, s[28:31], s48 offen lds
    s_add_u32 s48, s48, 8192
    s_cmp_eq_u32 s48, s50
    s_cmov_b32 s48, s63
    v_mfma_f32_32x32x16_bf16 v[136:151], v[16:19], v[28:31], v[136:151]
    buffer_load_dwordx4 v[52:55], v2, s[20:23], s49 offen sc1
    v_mfma_f32_32x32x16_bf16 v[152:167], v[16:19], v[32:35], v[152:167]
    buffer_load_dwordx4 v[56:59], v5, s[20:23], s49 offen sc1
    s_add_u32 s49, s49, 0x10000
    s_cmp_eq_u32 s49, s51
    s_cmov_b32 s49, s60
    s_waitcnt vmcnt(6)
    s_waitcnt lgkmcnt(0)
    ds_read_b64_tr_b16 v[12:13], v63 offset:0
    ds_read_b64_tr_b16 v[14:15], v63 offset:256
    ds_read_b64_tr_b16 v[16:17], v63 offset:512
    ds_read_b64_tr_b16 v[18:19], v63 offset:768
    v_mfma_f32_32x32x16_bf16 v[104:119], v[20:23], v[36:39], v[104:119]
    s_add_u32 m0, s64, 4096
    s_nop 0
    buffer_load_dwordx4 v8, s[28:31], s48 offen lds
    s_add_u32 s48, s48, 8192
    v_mfma_f32_32x32x16_bf16 v[120:135], v[20:23], v[40:43], v[120:135]
    s_add_u32 m0, s64, 5120
    s_nop 0
    buffer_load_dwordx4 v8, s[28:31], s48 offen lds
    s_add_u32 s48, s48, 8192
    s_cmp_eq_u32 s48, s50
    s_cmov_b32 s48, s63
    v_mfma_f32_32x32x16_bf16 v[136:151], v[24:27], v[36:39], v[136:151]
    buffer_load_dwordx4 v[28:31], v2, s[20:23], s49 offen sc1
    v_mfma_f32_32x32x16_bf16 v[152:167], v[24:27], v[40:43], v[152:167]
    buffer_load_dwordx4 v[32:35], v5, s[20:23], s49 offen sc1
    s_add_u32 s49, s49, 0x10000
    s_cmp_eq_u32 s49, s51
    s_cmov_b32 s49, s60
    s_waitcnt vmcnt(6)
    s_waitcnt lgkmcnt(0)
    ds_read_b64_tr_b16 v[20:21], v63 offset:2048
    ds_read_b64_tr_b16 v[22:23], v63 offset:2304
    ds_read_b64_tr_b16 v[24:25], v63 offset:2560
    ds_read_b64_tr_b16 v[26:27], v63 offset:2816
    v_mfma_f32_32x32x16_bf16 v[104:119], v[12:15], v[44:47], v[104:119]
    s_add_u32 m0, s64, 0
    s_nop 0
    buffer_load_dwordx4 v8, s[28:31], s48 offen lds
    s_add_u32 s48, s48, 8192
    v_mfma_f32_32x32x16_bf16 v[120:135], v[12:15], v[48:51], v[120:135]
    s_add_u32 m0, s64, 1024
    s_nop 0
    buffer_load_dwordx4 v8, s[28:31], s48 offen lds
    s_add_u32 s48, s48, 8192
    s_cmp_eq_u32 s48, s50
    s_cmov_b32 s48, s63
    v_mfma_f32_32x32x16_bf16 v[136:151], v[16:19], v[44:47], v[136:151]
    buffer_load_dwordx4 v[36:39], v2, s[20:23], s49 offen sc1
    v_mfma_f32_32x32x16_bf16 v[152:167], v[16:19], v[48:51], v[152:167]
    buffer_load_dwordx4 v[40:43], v5, s[20:23], s49 offen sc1
    s_add_u32 s49, s49, 0x10000
    s_cmp_eq_u32 s49, s51
    s_cmov_b32 s49, s60
    s_waitcnt vmcnt(6)
    s_waitcnt lgkmcnt(0)
    ds_read_b64_tr_b16 v[12:13], v63 offset:4096
    ds_read_b64_tr_b16 v[14:15], v63 offset:4352
    ds_read_b64_tr_b16 v[16:17], v63 offset:4608
    ds_read_b64_tr_b16 v[18:19], v63 offset:4864
    v_mfma_f32_32x32x16_bf16 v[104:119], v[20:23], v[52:55], v[104:119]
    s_add_u32 m0, s64, 2048
    s_nop 0
    buffer_load_dwordx4 v8, s[28:31], s48 offen lds
    s_add_u32 s48, s48, 8192
    v_mfma_f32_32x32x16_bf16 v[120:135], v[20:23], v[56:59], v[120:135]
    s_add_u32 m0, s64, 3072
    s_nop 0
    buffer_load_dwordx4 v8, s[28:31], s48 offen lds
    s_add_u32 s48, s48, 8192
    s_cmp_eq_u32 s48, s50
    s_cmov_b32 s48, s63
    v_mfma_f32_32x32x16_bf16 v[136:151], v[24:27], v[52:55], v[136:151]
    buffer_load_dwordx4 v[44:47], v2, s[20:23], s49 offen sc1
    v_mfma_f32_32x32x16_bf16 v[152:167], v[24:27], v[56:59], v[152:167]
    buffer_load_dwordx4 v[48:51], v5, s[20:23], s49 offen sc1
    s_add_u32 s49, s49, 0x10000
    s_cmp_eq_u32 s49, s51
    s_cmov_b32 s49, s60
    s_waitcnt vmcnt(6)
    s_waitcnt lgkmcnt(0)
    ds_read_b64_tr_b16 v[20:21], v63 offset:0
    ds_read_b64_tr_b16 v[22:23], v63 offset:256
    ds_read_b64_tr_b16 v[24:25], v63 offset:512
    ds_read_b64_tr_b16 v[26:27], v63 offset:768
    v_mfma_f32_32x32x16_bf16 v[104:119], v[12:15], v[28:31], v[104:119]
    s_add_u32 m0, s64, 4096
    s_nop 0
    buffer_load_dwordx4 v8, s[28:31], s48 offen lds
    s_add_u32 s48, s48, 8192
    v_mfma_f32_32x32x16_bf16 v[120:135], v[12:15], v[32:35], v[120:135]
    s_add_u32 m0, s64, 5120
    s_nop 0
    buffer_load_dwordx4 v8, s[28:31], s48 offen lds
    s_add_u32 s48, s48, 8192
    s_cmp_eq_u32 s48, s50
    s_cmov_b32 s48, s63
    v_mfma_f32_32x32x16_bf16 v[136:151], v[16:19], v[28:31], v[136:151]
    buffer_load_dwordx4 v[52:55], v2, s[20:23], s49 offen sc1
    v_mfma_f32_32x32x16_bf16 v[152:167], v[16:19], v[32:35], v[152:167]
    buffer_load_dwordx4 v[56:59], v5, s[20:23], s49 offen sc1
    s_add_u32 s49, s49, 0x10000
    s_cmp_eq_u32 s49, s51
    s_cmov_b32 s49, s60
    s_waitcnt vmcnt(6)
    s_waitcnt lgkmcnt(0)
    ds_read_b64_tr_b16 v[12:13], v63 offset:2048
    ds_read_b64_tr_b16 v[14:15], v63 offset:2304
    ds_read_b64_tr_b16 v[16:17], v63 offset:2560
    ds_read_b64_tr_b16 v[18:19], v63 offset:2816
    v_mfma_f32_32x32x16_bf16 v[104:119], v[20:23], v[36:39], v[104:119]
    s_add_u32 m0, s64, 0
    s_nop 0
    buffer_load_dwordx4 v8, s[28:31], s48 offen lds
    s_add_u32 s48, s48, 8192
    v_mfma_f32_32x32x16_bf16 v[120:135], v[20:23], v[40:43], v[120:135]
    s_add_u32 m0, s64, 1024
    s_nop 0
    buffer_load_dwordx4 v8, s[28:31], s48 offen lds
    s_add_u32 s48, s48, 8192
    s_cmp_eq_u32 s48, s50
    s_cmov_b32 s48, s63
    v_mfma_f32_32x32x16_bf16 v[136:151], v[24:27], v[36:39], v[136:151]
    buffer_load_dwordx4 v[28:31], v2, s[20:23], s49 offen sc1
    v_mfma_f32_32x32x16_bf16 v[152:167], v[24:27], v[40:43], v[152:167]
    buffer_load_dwordx4 v[32:35], v5, s[20:23], s49 offen sc1
    s_add_u32 s49, s49, 0x10000
    s_cmp_eq_u32 s49, s51
    s_cmov_b32 s49, s60
    s_waitcnt vmcnt(6)
    s_waitcnt lgkmcnt(0)
    ds_read_b64_tr_b16 v[20:21], v63 offset:4096
    ds_read_b64_tr_b16 v[22:23], v63 offset:4352
    ds_read_b64_tr_b16 v[24:25], v63 offset:4608
    ds_read_b64_tr_b16 v[26:27], v63 offset:4864
    v_mfma_f32_32x32x16_bf16 v[104:119], v[12:15], v[44:47], v[104:119]
    s_add_u32 m0, s64, 2048
    s_nop 0
    buffer_load_dwordx4 v8, s[28:31], s48 offen lds
    s_add_u32 s48, s48, 8192
    v_mfma_f32_32x32x16_bf16 v[120:135], v[12:15], v[48:51], v[120:135]
    s_add_u32 m0, s64, 3072
    s_nop 0
    buffer_load_dwordx4 v8, s[28:31], s48 offen lds
    s_add_u32 s48, s48, 8192
    s_cmp_eq_u32 s48, s50
    s_cmov_b32 s48, s63
    v_mfma_f32_32x32x16_bf16 v[136:151], v[16:19], v[44:47], v[136:151]
    buffer_load_dwordx4 v[36:39], v2, s[20:23], s49 offen sc1
    v_mfma_f32_32x32x16_bf16 v[152:167], v[16:19], v[48:51], v[152:167]
    buffer_load_dwordx4 v[40:43], v5, s[20:23], s49 offen sc1
    s_add_u32 s49, s49, 0x10000
    s_cmp_eq_u32 s49, s51
    s_cmov_b32 s49, s60
    s_waitcnt vmcnt(6)
    s_waitcnt lgkmcnt(0)
    ds_read_b64_tr_b16 v[12:13], v63 offset:0
    ds_read_b64_tr_b16 v[14:15], v63 offset:256
    ds_read_b64_tr_b16 v[16:17], v63 offset:512
    ds_read_b64_tr_b16 v[18:19], v63 offset:768
    v_mfma_f32_32x32x16_bf16 v[104:119], v[20:23], v[52:55], v[104:119]
    s_add_u32 m0, s64, 4096
    s_nop 0
    buffer_load_dwordx4 v8, s[28:31], s48 offen lds
    s_add_u32 s48, s48, 8192
    v_mfma_f32_32x32x16_bf16 v[120:135], v[20:23], v[56:59], v[120:135]
    s_add_u32 m0, s64, 5120
    s_nop 0
    buffer_load_dwordx4 v8, s[28:31], s48 offen lds
    s_add_u32 s48, s48, 8192
    s_cmp_eq_u32 s48, s50
    s_cmov_b32 s48, s63
    v_mfma_f32_32x32x16_bf16 v[136:151], v[24:27], v[52:55], v[136:151]
    buffer_load_dwordx4 v[44:47], v2, s[20:23], s49 offen sc1
    v_mfma_f32_32x32x16_bf16 v[152:167], v[24:27], v[56:59], v[152:167]
    buffer_load_dwordx4 v[48:51], v5, s[20:23], s49 offen sc1
    s_add_u32 s49, s49, 0x10000
    s_cmp_eq_u32 s49, s51
    s_cmov_b32 s49, s60
    s_waitcnt vmcnt(6)
    s_waitcnt lgkmcnt(0)
    ds_read_b64_tr_b16 v[20:21], v63 offset:2048
    ds_read_b64_tr_b16 v[22:23], v63 offset:2304
    ds_read_b64_tr_b16 v[24:25], v63 offset:2560
    ds_read_b64_tr_b16 v[26:27], v63 offset:2816
    v_mfma_f32_32x32x16_bf16 v[104:119], v[12:15], v[28:31], v[104:119]
    s_add_u32 m0, s64, 0
    s_nop 0
    buffer_load_dwordx4 v8, s[28:31], s48 offen lds
    s_add_u32 s48, s48, 8192
    v_mfma_f32_32x32x16_bf16 v[120:135], v[12:15], v[32:35], v[120:135]
    s_add_u32 m0, s64, 1024
    s_nop 0
    buffer_load_dwordx4 v8, s[28:31], s48 offen lds
    s_add_u32 s48, s48, 8192
    s_cmp_eq_u32 s48, s50
    s_cmov_b32 s48, s63
    v_mfma_f32_32x32x16_bf16 v[136:151], v[16:19], v[28:31], v[136:151]
    buffer_load_dwordx4 v[52:55], v2, s[20:23], s49 offen sc1
    v_mfma_f32_32x32x16_bf16 v[152:167], v[16:19], v[32:35], v[152:167]
    buffer_load_dwordx4 v[56:59], v5, s[20:23], s49 offen sc1
    s_add_u32 s49, s49, 0x10000
    s_cmp_eq_u32 s49, s51
    s_cmov_b32 s49, s60
    s_waitcnt vmcnt(6)
    s_waitcnt lgkmcnt(0)
    ds_read_b64_tr_b16 v[12:13], v63 offset:4096
    ds_read_b64_tr_b16 v[14:15], v63 offset:4352
    ds_read_b64_tr_b16 v[16:17], v63 offset:4608
    ds_read_b64_tr_b16 v[18:19], v63 offset:4864
    v_mfma_f32_32x32x16_bf16 v[104:119], v[20:23], v[36:39], v[104:119]
    s_add_u32 m0, s64, 2048
    s_nop 0
    buffer_load_dwordx4 v8, s[28:31], s48 offen lds
    s_add_u32 s48, s48, 8192
    v_mfma_f32_32x32x16_bf16 v[120:135], v[20:23], v[40:43], v[120:135]
    s_add_u32 m0, s64, 3072
    s_nop 0
    buffer_load_dwordx4 v8, s[28:31], s48 offen lds
    s_add_u32 s48, s48, 8192
    s_cmp_eq_u32 s48, s50
    s_cmov_b32 s48, s63
    v_mfma_f32_32x32x16_bf16 v[136:151], v[24:27], v[36:39], v[136:151]
    buffer_load_dwordx4 v[28:31], v2, s[20:23], s49 offen sc1
    v_mfma_f32_32x32x16_bf16 v[152:167], v[24:27], v[40:43], v[152:167]
    buffer_load_dwordx4 v[32:35], v5, s[20:23], s49 offen sc1
    s_add_u32 s49, s49, 0x10000
    s_cmp_eq_u32 s49, s51
    s_cmov_b32 s49, s60
    s_waitcnt vmcnt(6)
    s_waitcnt lgkmcnt(0)
    ds_read_b64_tr_b16 v[20:21], v63 offset:0
    ds_read_b64_tr_b16 v[22:23], v63 offset:256
    ds_read_b64_tr_b16 v[24:25], v63 offset:512
    ds_read_b64_tr_b16 v[26:27], v63 offset:768
    v_mfma_f32_32x32x16_bf16 v[104:119], v[12:15], v[44:47], v[104:119]
    s_add_u32 m0, s64, 4096
    s_nop 0
    buffer_load_dwordx4 v8, s[28:31], s48 offen lds
    s_add_u32 s48, s48, 8192
    v_mfma_f32_32x32x16_bf16 v[120:135], v[12:15], v[48:51], v[120:135]
    s_add_u32 m0, s64, 5120
    s_nop 0
    buffer_load_dwordx4 v8, s[28:31], s48 offen lds
    s_add_u32 s48, s48, 8192
    s_cmp_eq_u32 s48, s50
    s_cmov_b32 s48, s63
    v_mfma_f32_32x32x16_bf16 v[136:151], v[16:19], v[44:47], v[136:151]
    buffer_load_dwordx4 v[36:39], v2, s[20:23], s49 offen sc1
    v_mfma_f32_32x32x16_bf16 v[152:167], v[16:19], v[48:51], v[152:167]
    buffer_load_dwordx4 v[40:43], v5, s[20:23], s49 offen sc1
    s_add_u32 s49, s49, 0x10000
    s_cmp_eq_u32 s49, s51
    s_cmov_b32 s49, s60
    s_waitcnt vmcnt(6)
    s_waitcnt lgkmcnt(0)
    ds_read_b64_tr_b16 v[12:13], v63 offset:2048
    ds_read_b64_tr_b16 v[14:15], v63 offset:2304
    ds_read_b64_tr_b16 v[16:17], v63 offset:2560
    ds_read_b64_tr_b16 v[18:19], v63 offset:2816
    v_mfma_f32_32x32x16_bf16 v[104:119], v[20:23], v[52:55], v[104:119]
    s_add_u32 m0, s64, 0
    s_nop 0
    buffer_load_dwordx4 v8, s[28:31], s48 offen lds
    s_add_u32 s48, s48, 8192
    v_mfma_f32_32x32x16_bf16 v[120:135], v[20:23], v[56:59], v[120:135]
    s_add_u32 m0, s64, 1024
    s_nop 0
    buffer_load_dwordx4 v8, s[28:31], s48 offen lds
    s_add_u32 s48, s48, 8192
    s_cmp_eq_u32 s48, s50
    s_cmov_b32 s48, s63
    v_mfma_f32_32x32x16_bf16 v[136:151], v[24:27], v[52:55], v[136:151]
    buffer_load_dwordx4 v[44:47], v2, s[20:23], s49 offen sc1
    v_mfma_f32_32x32x16_bf16 v[152:167], v[24:27], v[56:59], v[152:167]
    buffer_load_dwordx4 v[48:51], v5, s[20:23], s49 offen sc1
    s_add_u32 s49, s49, 0x10000
    s_cmp_eq_u32 s49, s51
    s_cmov_b32 s49, s60
    s_waitcnt vmcnt(6)
    s_waitcnt lgkmcnt(0)
    ds_read_b64_tr_b16 v[20:21], v63 offset:4096
    ds_read_b64_tr_b16 v[22:23], v63 offset:4352
    ds_read_b64_tr_b16 v[24:25], v63 offset:4608
    ds_read_b64_tr_b16 v[26:27], v63 offset:4864
    v_mfma_f32_32x32x16_bf16 v[104:119], v[12:15], v[28:31], v[104:119]
    s_add_u32 m0, s64, 2048
    s_nop 0
    buffer_load_dwordx4 v8, s[28:31], s48 offen lds
    s_add_u32 s48, s48, 8192
    v_mfma_f32_32x32x16_bf16 v[120:135], v[12:15], v[32:35], v[120:135]
    s_add_u32 m0, s64, 3072
    s_nop 0
    buffer_load_dwordx4 v8, s[28:31], s48 offen lds
    s_add_u32 s48, s48, 8192
    s_cmp_eq_u32 s48, s50
    s_cmov_b32 s48, s63
    v_mfma_f32_32x32x16_bf16 v[136:151], v[16:19], v[28:31], v[136:151]
    buffer_load_dwordx4 v[52:55], v2, s[20:23], s49 offen sc1
    v_mfma_f32_32x32x16_bf16 v[152:167], v[16:19], v[32:35], v[152:167]
    buffer_load_dwordx4 v[56:59], v5, s[20:23], s49 offen sc1
    s_add_u32 s49, s49, 0x10000
    s_cmp_eq_u32 s49, s51
    s_cmov_b32 s49, s60
    s_waitcnt vmcnt(6)
    s_waitcnt lgkmcnt(0)
    ds_read_b64_tr_b16 v[12:13], v63 offset:0
    ds_read_b64_tr_b16 v[14:15], v63 offset:256
    ds_read_b64_tr_b16 v[16:17], v63 offset:512
    ds_read_b64_tr_b16 v[18:19], v63 offset:768
    v_mfma_f32_32x32x16_bf16 v[104:119], v[20:23], v[36:39], v[104:119]
    s_add_u32 m0, s64, 4096
    s_nop 0
    buffer_load_dwordx4 v8, s[28:31], s48 offen lds
    s_add_u32 s48, s48, 8192
    v_mfma_f32_32x32x16_bf16 v[120:135], v[20:23], v[40:43], v[120:135]
    s_add_u32 m0, s64, 5120
    s_nop 0
    buffer_load_dwordx4 v8, s[28:31], s48 offen lds
    s_add_u32 s48, s48, 8192
    s_cmp_eq_u32 s48, s50
    s_cmov_b32 s48, s63
    v_mfma_f32_32x32x16_bf16 v[136:151], v[24:27], v[36:39], v[136:151]
    buffer_load_dwordx4 v[28:31], v2, s[20:23], s49 offen sc1
    v_mfma_f32_32x32x16_bf16 v[152:167], v[24:27], v[40:43], v[152:167]
    buffer_load_dwordx4 v[32:35], v5, s[20:23], s49 offen sc1
    s_add_u32 s49, s49, 0x10000
    s_cmp_eq_u32 s49, s51
    s_cmov_b32 s49, s60
    s_waitcnt vmcnt(6)
    s_waitcnt lgkmcnt(0)
    ds_read_b64_tr_b16 v[20:21], v63 offset:2048
    ds_read_b64_tr_b16 v[22:23], v63 offset:2304
    ds_read_b64_tr_b16 v[24:25], v63 offset:2560
    ds_read_b64_tr_b16 v[26:27], v63 offset:2816
    v_mfma_f32_32x32x16_bf16 v[104:119], v[12:15], v[44:47], v[104:119]
    s_add_u32 m0, s64, 0
    s_nop 0
    buffer_load_dwordx4 v8, s[28:31], s48 offen lds
    s_add_u32 s48, s48, 8192
    v_mfma_f32_32x32x16_bf16 v[120:135], v[12:15], v[48:51], v[120:135]
    s_add_u32 m0, s64, 1024
    s_nop 0
    buffer_load_dwordx4 v8, s[28:31], s48 offen lds
    s_add_u32 s48, s48, 8192
    s_cmp_eq_u32 s48, s50
    s_cmov_b32 s48, s63
    v_mfma_f32_32x32x16_bf16 v[136:151], v[16:19], v[44:47], v[136:151]
    buffer_load_dwordx4 v[36:39], v2, s[20:23], s49 offen sc1
    v_mfma_f32_32x32x16_bf16 v[152:167], v[16:19], v[48:51], v[152:167]
    buffer_load_dwordx4 v[40:43], v5, s[20:23], s49 offen sc1
    s_add_u32 s49, s49, 0x10000
    s_cmp_eq_u32 s49, s51
    s_cmov_b32 s49, s60
    s_waitcnt vmcnt(6)
    s_waitcnt lgkmcnt(0)
    ds_read_b64_tr_b16 v[12:13], v63 offset:4096
    ds_read_b64_tr_b16 v[14:15], v63 offset:4352
    ds_read_b64_tr_b16 v[16:17], v63 offset:4608
    ds_read_b64_tr_b16 v[18:19], v63 offset:4864
    v_mfma_f32_32x32x16_bf16 v[104:119], v[20:23], v[52:55], v[104:119]
    s_add_u32 m0, s64, 2048
    s_add_u32 s79, s62, 0
    buffer_load_dwordx4 v8, s[32:35], s79 offen lds
    v_mfma_f32_32x32x16_bf16 v[120:135], v[20:23], v[56:59], v[120:135]
    s_add_u32 m0, s64, 3072
    s_add_u32 s79, s62, 8192
    buffer_load_dwordx4 v8, s[32:35], s79 offen lds
    v_mfma_f32_32x32x16_bf16 v[136:151], v[24:27], v[52:55], v[136:151]
    v_mfma_f32_32x32x16_bf16 v[152:167], v[24:27], v[56:59], v[152:167]
    s_waitcnt vmcnt(4)
    s_waitcnt lgkmcnt(0)
    ds_read_b64_tr_b16 v[20:21], v63 offset:0
    ds_read_b64_tr_b16 v[22:23], v63 offset:256
    ds_read_b64_tr_b16 v[24:25], v63 offset:512
    ds_read_b64_tr_b16 v[26:27], v63 offset:768
    v_mfma_f32_32x32x16_bf16 v[104:119], v[12:15], v[28:31], v[104:119]
    s_add_u32 m0, s64, 4096
    s_add_u32 s79, s62, 16384
    buffer_load_dwordx4 v8, s[32:35], s79 offen lds
    v_mfma_f32_32x32x16_bf16 v[120:135], v[12:15], v[32:35], v[120:135]
    s_add_u32 m0, s64, 5120
    s_add_u32 s79, s62, 24576
    buffer_load_dwordx4 v8, s[32:35], s79 offen lds
    v_mfma_f32_32x32x16_bf16 v[136:151], v[16:19], v[28:31], v[136:151]
    v_mfma_f32_32x32x16_bf16 v[152:167], v[16:19], v[32:35], v[152:167]
    s_waitcnt vmcnt(2)
    s_waitcnt lgkmcnt(0)
    v_mfma_f32_32x32x16_bf16 v[104:119], v[20:23], v[36:39], v[104:119]
    s_add_u32 m0, s64, 0
    s_add_u32 s79, s62, 32768
    buffer_load_dwordx4 v8, s[32:35], s79 offen lds
    v_mfma_f32_32x32x16_bf16 v[120:135], v[20:23], v[40:43], v[120:135]
    s_add_u32 m0, s64, 1024
    s_add_u32 s79, s62, 40960
    buffer_load_dwordx4 v8, s[32:35], s79 offen lds
    v_mfma_f32_32x32x16_bf16 v[136:151], v[24:27], v[36:39], v[136:151]
    v_mfma_f32_32x32x16_bf16 v[152:167], v[24:27], v[40:43], v[152:167]
L_g_dskip:
    s_setprio 3
    v_sub_f32 v6, 1.0, v10
    v_sub_f32 v7, 1.0, v11
    ds_read_b64_tr_b16 v[40:41], v9 offset:2048
    ds_read_b64_tr_b16 v[42:43], v9 offset:3072
    ds_read_b64_tr_b16 v[44:45], v9 offset:2560
    ds_read_b64_tr_b16 v[46:47], v9 offset:3584
    s_waitcnt vmcnt(2)
    ds_read_b64_tr_b16 v[48:49], v9 offset:4096
    ds_read_b64_tr_b16 v[50:51], v9 offset:5120
    ds_read_b64_tr_b16 v[52:53], v9 offset:4608
    ds_read_b64_tr_b16 v[54:55], v9 offset:5632
    s_waitcnt vmcnt(0)
    ds_read_b64_tr_b16 v[56:57], v9 offset:0
    ds_read_b64_tr_b16 v[58:59], v9 offset:1024
    ds_read_b64_tr_b16 v[60:61], v9 offset:512
    ds_read_b64_tr_b16 v[62:63], v9 offset:1536
    v_lshrrev_b32 v4, 1, v1
    v_lshlrev_b32 v4, 16, v4
    v_and_b32 v0, 1, v1
    v_lshl_add_u32 v0, v0, 10, v4
    v_add_u32 v0, 1020, v0
    s_xor_b32 s79, s3, 0
    s_lshr_b32 s80, s79, 1
    s_and_b32 s79, s79, 1
    s_lshl1_add_u32 s79, s79, s80
    s_lshl2_add_u32 s79, s3, s79
    s_mul_i32 s48, s79, 4224
    s_xor_b32 s79, s3, 1
    s_lshr_b32 s80, s79, 1
    s_and_b32 s79, s79, 1
    s_lshl1_add_u32 s79, s79, s80
    s_lshl2_add_u32 s79, s3, s79
    s_mul_i32 s49, s79, 4224
    s_xor_b32 s79, s3, 2
    s_lshr_b32 s80, s79, 1
    s_and_b32 s79, s79, 1
    s_lshl1_add_u32 s79, s79, s80
    s_lshl2_add_u32 s79, s3, s79
    s_mul_i32 s50, s79, 4224
    s_xor_b32 s79, s3, 3
    s_lshr_b32 s80, s79, 1
    s_and_b32 s79, s79, 1
    s_lshl1_add_u32 s79, s79, s80
    s_lshl2_add_u32 s79, s3, s79
    s_mul_i32 s51, s79, 4224
    s_lshl_b32 s74, s6, 16
    s_lshl_b32 s80, s3, 14
    s_add_u32 s74, s74, s80
    s_lshl_b32 s80, s7, 7
    s_add_u32 s74, s74, s80
    s_waitcnt lgkmcnt(0)
    s_barrier
    s_add_u32 s79, s75, 65536
    buffer_load_dwordx4 v[8:11], v2, s[16:19], s79 offen sc1
    buffer_load_dwordx4 v[12:15], v5, s[16:19], s79 offen sc1
    s_add_u32 s79, s75, 196608
    buffer_load_dwordx4 v[16:19], v2, s[16:19], s79 offen sc1
    buffer_load_dwordx4 v[20:23], v5, s[16:19], s79 offen sc1
    s_add_u32 s79, s75, 327680
    buffer_load_dwordx4 v[24:27], v2, s[16:19], s79 offen sc1
    buffer_load_dwordx4 v[28:31], v5, s[16:19], s79 offen sc1
    s_add_u32 s79, s75, 458752
    buffer_load_dwordx4 v[32:35], v2, s[16:19], s79 offen sc1
    buffer_load_dwordx4 v[36:39], v5, s[16:19], s79 offen sc1
    v_pk_mul_f32 v[104:105], v[104:105], v[6:7] op_sel_hi:[1,0]
    v_pk_mul_f32 v[106:107], v[106:107], v[6:7] op_sel_hi:[1,0]
    v_pk_mul_f32 v[108:109], v[108:109], v[6:7] op_sel_hi:[1,0]
    v_pk_mul_f32 v[110:111], v[110:111], v[6:7] op_sel_hi:[1,0]
    v_pk_mul_f32 v[112:113], v[112:113], v[6:7] op_sel_hi:[1,0]
    v_pk_mul_f32 v[114:115], v[114:115], v[6:7] op_sel_hi:[1,0]
    v_pk_mul_f32 v[116:117], v[116:117], v[6:7] op_sel_hi:[1,0]
    v_pk_mul_f32 v[118:119], v[118:119], v[6:7] op_sel_hi:[1,0]
    v_pk_mul_f32 v[120:121], v[120:121], v[6:7] op_sel:[0,1] op_sel_hi:[1,1]
    v_pk_mul_f32 v[122:123], v[122:123], v[6:7] op_sel:[0,1] op_sel_hi:[1,1]
    v_pk_mul_f32 v[124:125], v[124:125], v[6:7] op_sel:[0,1] op_sel_hi:[1,1]
    v_pk_mul_f32 v[126:127], v[126:127], v[6:7] op_sel:[0,1] op_sel_hi:[1,1]
    v_pk_mul_f32 v[128:129], v[128:129], v[6:7] op_sel:[0,1] op_sel_hi:[1,1]
    v_pk_mul_f32 v[130:131], v[130:131], v[6:7] op_sel:[0,1] op_sel_hi:[1,1]
    v_pk_mul_f32 v[132:133], v[132:133], v[6:7] op_sel:[0,1] op_sel_hi:[1,1]
    v_pk_mul_f32 v[134:135], v[134:135], v[6:7] op_sel:[0,1] op_sel_hi:[1,1]
    v_pk_mul_f32 v[136:137], v[136:137], v[6:7] op_sel_hi:[1,0]
    v_pk_mul_f32 v[138:139], v[138:139], v[6:7] op_sel_hi:[1,0]
    v_pk_mul_f32 v[140:141], v[140:141], v[6:7] op_sel_hi:[1,0]
    v_pk_mul_f32 v[142:143], v[142:143], v[6:7] op_sel_hi:[1,0]
    v_pk_mul_f32 v[144:145], v[144:145], v[6:7] op_sel_hi:[1,0]
    v_pk_mul_f32 v[146:147], v[146:147], v[6:7] op_sel_hi:[1,0]
    v_pk_mul_f32 v[148:149], v[148:149], v[6:7] op_sel_hi:[1,0]
    v_pk_mul_f32 v[150:151], v[150:151], v[6:7] op_sel_hi:[1,0]
    v_pk_mul_f32 v[152:153], v[152:153], v[6:7] op_sel:[0,1] op_sel_hi:[1,1]
    v_pk_mul_f32 v[154:155], v[154:155], v[6:7] op_sel:[0,1] op_sel_hi:[1,1]
    v_pk_mul_f32 v[156:157], v[156:157], v[6:7] op_sel:[0,1] op_sel_hi:[1,1]
    v_pk_mul_f32 v[158:159], v[158:159], v[6:7] op_sel:[0,1] op_sel_hi:[1,1]
    v_pk_mul_f32 v[160:161], v[160:161], v[6:7] op_sel:[0,1] op_sel_hi:[1,1]
    v_pk_mul_f32 v[162:163], v[162:163], v[6:7] op_sel:[0,1] op_sel_hi:[1,1]
    v_pk_mul_f32 v[164:165], v[164:165], v[6:7] op_sel:[0,1] op_sel_hi:[1,1]
    v_pk_mul_f32 v[166:167], v[166:167], v[6:7] op_sel:[0,1] op_sel_hi:[1,1]
L_o_w0:
    s_waitcnt vmcnt(6)
    v_max3_u32 v6, v8, v9, v10
    v_max3_u32 v7, v11, v12, v13
    v_max3_u32 v6, v6, v14, v15
    v_max_u32 v6, v6, v7
    v_cmp_eq_u32 vcc, -1, v6
    s_cbranch_vccnz L_o_r0
L_o_k0:
    v_mfma_f32_32x32x16_bf16 v[120:135], v[48:51], v[12:15], v[120:135]
    v_mfma_f32_32x32x16_bf16 v[136:151], v[52:55], v[8:11], v[136:151]
    v_mfma_f32_32x32x16_bf16 v[152:167], v[52:55], v[12:15], v[152:167]
    v_mfma_f32_32x32x16_bf16 v[104:119], v[48:51], v[8:11], v[104:119]
    s_add_u32 s79, s75, 0
    buffer_load_dwordx4 v[8:11], v2, s[16:19], s79 offen sc1
    buffer_load_dwordx4 v[12:15], v5, s[16:19], s79 offen sc1
L_o_w1:
    s_waitcnt vmcnt(6)
    v_max3_u32 v6, v16, v17, v18
    v_max3_u32 v7, v19, v20, v21
    v_max3_u32 v6, v6, v22, v23
    v_max_u32 v6, v6, v7
    v_cmp_eq_u32 vcc, -1, v6
    s_cbranch_vccnz L_o_r1
L_o_k1:
    v_mfma_f32_32x32x16_bf16 v[120:135], v[64:67], v[20:23], v[120:135]
    v_mfma_f32_32x32x16_bf16 v[136:151], v[68:71], v[16:19], v[136:151]
    v_mfma_f32_32x32x16_bf16 v[152:167], v[68:71], v[20:23], v[152:167]
    v_mfma_f32_32x32x16_bf16 v[104:119], v[64:67], v[16:19], v[104:119]
    s_add_u32 s79, s75, 131072
    buffer_load_dwordx4 v[16:19], v2, s[16:19], s79 offen sc1
    buffer_load_dwordx4 v[20:23], v5, s[16:19], s79 offen sc1
L_o_w2:
    s_waitcnt vmcnt(6)
    v_max3_u32 v6, v24, v25, v26
    v_max3_u32 v7, v27, v28, v29
    v_max3_u32 v6, v6, v30, v31
    v_max_u32 v6, v6, v7
    v_cmp_eq_u32 vcc, -1, v6
    s_cbranch_vccnz L_o_r2
L_o_k2:
    v_mfma_f32_32x32x16_bf16 v[120:135], v[80:83], v[28:31], v[120:135]
    v_mfma_f32_32x32x16_bf16 v[136:151], v[84:87], v[24:27], v[136:151]
    v_mfma_f32_32x32x16_bf16 v[152:167], v[84:87], v[28:31], v[152:167]
    v_mfma_f32_32x32x16_bf16 v[104:119], v[80:83], v[24:27], v[104:119]
    s_add_u32 s79, s75, 262144
    buffer_load_dwordx4 v[24:27], v2, s[16:19], s79 offen sc1
    buffer_load_dwordx4 v[28:31], v5, s[16:19], s79 offen sc1
L_o_w3:
    s_waitcnt vmcnt(6)
    v_max3_u32 v6, v32, v33, v34
    v_max3_u32 v7, v35, v36, v37
    v_max3_u32 v6, v6, v38, v39
    v_max_u32 v6, v6, v7
    v_cmp_eq_u32 vcc, -1, v6
    s_cbranch_vccnz L_o_r3
L_o_k3:
    v_mfma_f32_32x32x16_bf16 v[120:135], v[96:99], v[36:39], v[120:135]
    v_mfma_f32_32x32x16_bf16 v[136:151], v[100:103], v[32:35], v[136:151]
    v_mfma_f32_32x32x16_bf16 v[152:167], v[100:103], v[36:39], v[152:167]
    v_mfma_f32_32x32x16_bf16 v[104:119], v[96:99], v[32:35], v[104:119]
    s_add_u32 s79, s75, 393216
    buffer_load_dwordx4 v[32:35], v2, s[16:19], s79 offen sc1
    buffer_load_dwordx4 v[36:39], v5, s[16:19], s79 offen sc1
L_o_w4:
    s_waitcnt vmcnt(6)
    v_max3_u32 v6, v8, v9, v10
    v_max3_u32 v7, v11, v12, v13
    v_max3_u32 v6, v6, v14, v15
    v_max_u32 v6, v6, v7
    v_cmp_eq_u32 vcc, -1, v6
    s_cbranch_vccnz L_o_r4
L_o_k4:
    v_mfma_f32_32x32x16_bf16 v[120:135], v[40:43], v[12:15], v[120:135]
    v_mfma_f32_32x32x16_bf16 v[136:151], v[44:47], v[8:11], v[136:151]
    v_mfma_f32_32x32x16_bf16 v[152:167], v[44:47], v[12:15], v[152:167]
    v_mfma_f32_32x32x16_bf16 v[104:119], v[40:43], v[8:11], v[104:119]
L_o_w5:
    s_waitcnt vmcnt(4)
    v_max3_u32 v6, v16, v17, v18
    v_max3_u32 v7, v19, v20, v21
    v_max3_u32 v6, v6, v22, v23
    v_max_u32 v6, v6, v7
    v_cmp_eq_u32 vcc, -1, v6
    s_cbranch_vccnz L_o_r5
L_o_k5:
    v_mfma_f32_32x32x16_bf16 v[120:135], v[56:59], v[20:23], v[120:135]
    v_mfma_f32_32x32x16_bf16 v[136:151], v[60:63], v[16:19], v[136:151]
    v_mfma_f32_32x32x16_bf16 v[152:167], v[60:63], v[20:23], v[152:167]
    v_mfma_f32_32x32x16_bf16 v[104:119], v[56:59], v[16:19], v[104:119]
L_o_w6:
    s_waitcnt vmcnt(2)
    v_max3_u32 v6, v24, v25, v26
    v_max3_u32 v7, v27, v28, v29
    v_max3_u32 v6, v6, v30, v31
    v_max_u32 v6, v6, v7
    v_cmp_eq_u32 vcc, -1, v6
    s_cbranch_vccnz L_o_r6
L_o_k6:
    v_mfma_f32_32x32x16_bf16 v[120:135], v[72:75], v[28:31], v[120:135]
    v_mfma_f32_32x32x16_bf16 v[136:151], v[76:79], v[24:27], v[136:151]
    v_mfma_f32_32x32x16_bf16 v[152:167], v[76:79], v[28:31], v[152:167]
    v_mfma_f32_32x32x16_bf16 v[104:119], v[72:75], v[24:27], v[104:119]
L_o_w7:
    s_waitcnt vmcnt(0)
    v_max3_u32 v6, v32, v33, v34
    v_max3_u32 v7, v35, v36, v37
    v_max3_u32 v6, v6, v38, v39
    v_max_u32 v6, v6, v7
    v_cmp_eq_u32 vcc, -1, v6
    s_cbranch_vccnz L_o_r7
L_o_k7:
    v_mfma_f32_32x32x16_bf16 v[120:135], v[88:91], v[36:39], v[120:135]
    v_mfma_f32_32x32x16_bf16 v[136:151], v[92:95], v[32:35], v[136:151]
    v_mfma_f32_32x32x16_bf16 v[152:167], v[92:95], v[36:39], v[152:167]
    v_mfma_f32_32x32x16_bf16 v[104:119], v[88:91], v[32:35], v[104:119]
    v_lshlrev_b32 v4, 4, v1
    v_lshrrev_b32 v3, 3, v1
    v_add_u32 v9, s49, v4
    v_add_u32 v10, s50, v4
    v_add_u32 v11, s51, v4
    v_add_u32 v8, s48, v4
    s_nop 3
    ds_write_b128 v9, v[120:123] offset:0
    ds_write_b128 v9, v[124:127] offset:1056
    ds_write_b128 v9, v[128:131] offset:2112
    ds_write_b128 v9, v[132:135] offset:3168
    ds_write_b128 v10, v[136:139] offset:0
    ds_write_b128 v10, v[140:143] offset:1056
    ds_write_b128 v10, v[144:147] offset:2112
    ds_write_b128 v10, v[148:151] offset:3168
    ds_write_b128 v11, v[152:155] offset:0
    ds_write_b128 v11, v[156:159] offset:1056
    ds_write_b128 v11, v[160:163] offset:2112
    ds_write_b128 v11, v[164:167] offset:3168
    ds_write_b128 v8, v[104:107] offset:0
    ds_write_b128 v8, v[108:111] offset:1056
    ds_write_b128 v8, v[112:115] offset:2112
    ds_write_b128 v8, v[116:119] offset:3168
    v_and_b32 v7, 7, v1
    v_mul_u32_u24 v6, 1056, v7
    v_lshl_add_u32 v6, v3, 4, v6
    s_lshr_b32 s79, s3, 1
    s_mul_i32 s79, s79, 8448
    s_and_b32 s80, s3, 1
    s_lshl_b32 s80, s80, 8
    s_add_u32 s79, s79, s80
    v_add_u32 v6, s79, v6
    v_lshlrev_b32 v3, 10, v3
    v_lshl_add_u32 v3, v7, 4, v3
    s_add_u32 s75, s74, 8192
    s_waitcnt lgkmcnt(0)
    s_barrier
    ds_read_b128 v[104:107], v6 offset:0
    ds_read_b128 v[108:111], v6 offset:512
    ds_read_b128 v[112:115], v6 offset:16896
    ds_read_b128 v[116:119], v6 offset:17408
    ds_read_b128 v[120:123], v6 offset:33792
    ds_read_b128 v[124:127], v6 offset:34304
    ds_read_b128 v[128:131], v6 offset:50688
    ds_read_b128 v[132:135], v6 offset:51200
    ds_read_b128 v[136:139], v6 offset:128
    ds_read_b128 v[140:143], v6 offset:640
    ds_read_b128 v[144:147], v6 offset:17024
    ds_read_b128 v[148:151], v6 offset:17536
    ds_read_b128 v[152:155], v6 offset:33920
    ds_read_b128 v[156:159], v6 offset:34432
    ds_read_b128 v[160:163], v6 offset:50816
    ds_read_b128 v[164:167], v6 offset:51328
    s_waitcnt lgkmcnt(12)
    v_pk_add_f32 v[104:105], v[104:105], v[112:113]
    v_pk_add_f32 v[106:107], v[106:107], v[114:115]
    v_pk_add_f32 v[108:109], v[108:109], v[116:117]
    v_pk_add_f32 v[110:111], v[110:111], v[118:119]
    s_waitcnt lgkmcnt(8)
    v_pk_add_f32 v[120:121], v[120:121], v[128:129]
    v_pk_add_f32 v[122:123], v[122:123], v[130:131]
    v_pk_add_f32 v[124:125], v[124:125], v[132:133]
    v_pk_add_f32 v[126:127], v[126:127], v[134:135]
    v_pk_add_f32 v[104:105], v[104:105], v[120:121]
    v_pk_add_f32 v[106:107], v[106:107], v[122:123]
    v_pk_add_f32 v[108:109], v[108:109], v[124:125]
    v_pk_add_f32 v[110:111], v[110:111], v[126:127]
    v_cvt_pk_bf16_f32 v16, v104, v105
    v_cvt_pk_bf16_f32 v17, v106, v107
    v_cvt_pk_bf16_f32 v18, v108, v109
    v_cvt_pk_bf16_f32 v19, v110, v111
    buffer_store_dwordx4 v[16:19], v3, s[36:39], s74 offen sc1
    s_waitcnt lgkmcnt(4)
    v_pk_add_f32 v[136:137], v[136:137], v[144:145]
    v_pk_add_f32 v[138:139], v[138:139], v[146:147]
    v_pk_add_f32 v[140:141], v[140:141], v[148:149]
    v_pk_add_f32 v[142:143], v[142:143], v[150:151]
    s_waitcnt lgkmcnt(0)
    v_pk_add_f32 v[152:153], v[152:153], v[160:161]
    v_pk_add_f32 v[154:155], v[154:155], v[162:163]
    v_pk_add_f32 v[156:157], v[156:157], v[164:165]
    v_pk_add_f32 v[158:159], v[158:159], v[166:167]
    v_pk_add_f32 v[136:137], v[136:137], v[152:153]
    v_pk_add_f32 v[138:139], v[138:139], v[154:155]
    v_pk_add_f32 v[140:141], v[140:141], v[156:157]
    v_pk_add_f32 v[142:143], v[142:143], v[158:159]
    v_cvt_pk_bf16_f32 v20, v136, v137
    v_cvt_pk_bf16_f32 v21, v138, v139
    v_cvt_pk_bf16_f32 v22, v140, v141
    v_cvt_pk_bf16_f32 v23, v142, v143
    buffer_store_dwordx4 v[20:23], v3, s[36:39], s75 offen sc1
    s_or_b32 s79, s2, s3
    s_cmp_lg_u32 s79, 0
    s_cbranch_scc1 L_g_noep
    s_mov_b32 s79, 0xdf0000
    v_mov_b32 v3, s70
    s_mov_b64 exec, 1
    buffer_store_dword v3, off, s[16:19], s79 sc1
    s_mov_b64 exec, -1
L_g_noep:
L_end:
    s_endpgm
L_gt2:
    v_lshrrev_b32 v26, 5, v1
    v_lshlrev_b32 v26, 4, v26
    s_add_u32 s78, s46, 7
    s_and_b32 s78, s78, 7
    s_lshl_b32 s78, s78, 7
    buffer_load_dwordx4 v[72:75], v26, s[40:43], s78 offen offset:0
    buffer_load_dwordx4 v[76:79], v26, s[40:43], s78 offen offset:32
    buffer_load_dwordx4 v[80:83], v26, s[40:43], s78 offen offset:64
    buffer_load_dwordx4 v[84:87], v26, s[40:43], s78 offen offset:96
    s_add_u32 s78, s46, 8
    s_and_b32 s78, s78, 7
    s_lshl_b32 s78, s78, 7
    buffer_load_dwordx4 v[88:91], v26, s[40:43], s78 offen offset:0
    buffer_load_dwordx4 v[92:95], v26, s[40:43], s78 offen offset:32
    buffer_load_dwordx4 v[96:99], v26, s[40:43], s78 offen offset:64
    buffer_load_dwordx4 v[100:103], v26, s[40:43], s78 offen offset:96
    s_branch L_gtr2
L_gt3:
    v_and_b32 v15, 31, v1
    v_lshrrev_b32 v26, 5, v1
    v_bfe_u32 v22, v1, 1, 3
    v_xor_b32 v3, v26, v22
    v_lshlrev_b32 v3, 4, v3
    v_lshl_add_u32 v22, v15, 7, v3
    s_lshl_b32 s78, s3, 12
    v_add_u32 v22, s78, v22
    v_xor_b32 v23, 32, v22
    v_xor_b32 v24, 64, v22
    v_xor_b32 v25, 96, v22
    s_branch L_gtr3
L_gt4:
    v_lshrrev_b32 v26, 5, v1
    v_lshlrev_b32 v26, 4, v26
    s_add_u32 s78, s46, 9
    s_and_b32 s78, s78, 7
    s_lshl_b32 s78, s78, 7
    buffer_load_dwordx4 v[104:107], v26, s[40:43], s78 offen offset:0
    buffer_load_dwordx4 v[108:111], v26, s[40:43], s78 offen offset:32
    buffer_load_dwordx4 v[112:115], v26, s[40:43], s78 offen offset:64
    buffer_load_dwordx4 v[116:119], v26, s[40:43], s78 offen offset:96
    s_add_u32 s78, s46, 10
    s_and_b32 s78, s78, 7
    s_lshl_b32 s78, s78, 7
    buffer_load_dwordx4 v[120:123], v26, s[40:43], s78 offen offset:0
    buffer_load_dwordx4 v[124:127], v26, s[40:43], s78 offen offset:32
    buffer_load_dwordx4 v[128:131], v26, s[40:43], s78 offen offset:64
    buffer_load_dwordx4 v[132:135], v26, s[40:43], s78 offen offset:96
    s_branch L_gtr4
L_gt5:
    ds_read_b128 v[152:155], v22 offset:0
    ds_read_b128 v[156:159], v23 offset:0
    ds_read_b128 v[160:163], v24 offset:0
    ds_read_b128 v[164:167], v25 offset:0
    s_waitcnt lgkmcnt(3)
    v_mfma_f32_32x32x16_bf16 v[136:151], v[72:75], v[152:155], 0
    ds_read_b128 v[152:155], v22 offset:8192
    s_waitcnt lgkmcnt(3)
    v_mfma_f32_32x32x16_bf16 v[136:151], v[76:79], v[156:159], v[136:151]
    ds_read_b128 v[156:159], v23 offset:8192
    s_waitcnt lgkmcnt(3)
    v_mfma_f32_32x32x16_bf16 v[136:151], v[80:83], v[160:163], v[136:151]
    ds_read_b128 v[160:163], v24 offset:8192
    s_waitcnt lgkmcnt(3)
    v_mfma_f32_32x32x16_bf16 v[136:151], v[84:87], v[164:167], v[136:151]
    ds_read_b128 v[164:167], v25 offset:8192
    s_waitcnt lgkmcnt(3)
    v_mfma_f32_32x32x16_bf16 v[136:151], v[88:91], v[152:155], v[136:151]
    s_waitcnt lgkmcnt(2)
    v_mfma_f32_32x32x16_bf16 v[136:151], v[92:95], v[156:159], v[136:151]
    s_waitcnt lgkmcnt(1)
    v_mfma_f32_32x32x16_bf16 v[136:151], v[96:99], v[160:163], v[136:151]
    s_waitcnt lgkmcnt(0)
    v_mfma_f32_32x32x16_bf16 v[136:151], v[100:103], v[164:167], v[136:151]
    s_branch L_gtr5
L_gt6:
    v_lshrrev_b32 v26, 5, v1
    v_lshlrev_b32 v26, 4, v26
    s_add_u32 s78, s46, 11
    s_and_b32 s78, s78, 7
    s_lshl_b32 s78, s78, 7
    buffer_load_dwordx4 v[72:75], v26, s[40:43], s78 offen offset:0
    buffer_load_dwordx4 v[76:79], v26, s[40:43], s78 offen offset:32
    buffer_load_dwordx4 v[80:83], v26, s[40:43], s78 offen offset:64
    buffer_load_dwordx4 v[84:87], v26, s[40:43], s78 offen offset:96
    s_add_u32 s78, s46, 12
    s_and_b32 s78, s78, 7
    s_lshl_b32 s78, s78, 7
    buffer_load_dwordx4 v[88:91], v26, s[40:43], s78 offen offset:0
    buffer_load_dwordx4 v[92:95], v26, s[40:43], s78 offen offset:32
    buffer_load_dwordx4 v[96:99], v26, s[40:43], s78 offen offset:64
    buffer_load_dwordx4 v[100:103], v26, s[40:43], s78 offen offset:96
    s_branch L_gtr6
L_gt7:
    ds_read_b128 v[152:155], v22 offset:16384
    ds_read_b128 v[156:159], v23 offset:16384
    ds_read_b128 v[160:163], v24 offset:16384
    ds_read_b128 v[164:167], v25 offset:16384
    s_waitcnt lgkmcnt(3)
    v_mfma_f32_32x32x16_bf16 v[136:151], v[104:107], v[152:155], v[136:151]
    ds_read_b128 v[152:155], v22 offset:24576
    s_waitcnt lgkmcnt(3)
    v_mfma_f32_32x32x16_bf16 v[136:151], v[108:111], v[156:159], v[136:151]
    ds_read_b128 v[156:159], v23 offset:24576
    s_waitcnt lgkmcnt(3)
    v_mfma_f32_32x32x16_bf16 v[136:151], v[112:115], v[160:163], v[136:151]
    ds_read_b128 v[160:163], v24 offset:24576
    s_waitcnt lgkmcnt(3)
    v_mfma_f32_32x32x16_bf16 v[136:151], v[116:119], v[164:167], v[136:151]
    ds_read_b128 v[164:167], v25 offset:24576
    s_waitcnt lgkmcnt(3)
    v_mfma_f32_32x32x16_bf16 v[136:151], v[120:123], v[152:155], v[136:151]
    s_waitcnt lgkmcnt(2)
    v_mfma_f32_32x32x16_bf16 v[136:151], v[124:127], v[156:159], v[136:151]
    s_waitcnt lgkmcnt(1)
    v_mfma_f32_32x32x16_bf16 v[136:151], v[128:131], v[160:163], v[136:151]
    s_waitcnt lgkmcnt(0)
    v_mfma_f32_32x32x16_bf16 v[136:151], v[132:135], v[164:167], v[136:151]
    s_branch L_gtr7
L_gt8:
    v_lshrrev_b32 v26, 5, v1
    v_lshlrev_b32 v26, 4, v26
    s_add_u32 s78, s46, 13
    s_and_b32 s78, s78, 7
    s_lshl_b32 s78, s78, 7
    buffer_load_dwordx4 v[104:107], v26, s[40:43], s78 offen offset:0
    buffer_load_dwordx4 v[108:111], v26, s[40:43], s78 offen offset:32
    buffer_load_dwordx4 v[112:115], v26, s[40:43], s78 offen offset:64
    buffer_load_dwordx4 v[116:119], v26, s[40:43], s78 offen offset:96
    s_add_u32 s78, s46, 14
    s_and_b32 s78, s78, 7
    s_lshl_b32 s78, s78, 7
    buffer_load_dwordx4 v[120:123], v26, s[40:43], s78 offen offset:0
    buffer_load_dwordx4 v[124:127], v26, s[40:43], s78 offen offset:32
    buffer_load_dwordx4 v[128:131], v26, s[40:43], s78 offen offset:64
    buffer_load_dwordx4 v[132:135], v26, s[40:43], s78 offen offset:96
    s_branch L_gtr8
L_gt9:
    ds_read_b128 v[152:155], v22 offset:32768
    ds_read_b128 v[156:159], v23 offset:32768
    ds_read_b128 v[160:163], v24 offset:32768
    ds_read_b128 v[164:167], v25 offset:32768
    s_waitcnt lgkmcnt(3)
    v_mfma_f32_32x32x16_bf16 v[136:151], v[72:75], v[152:155], v[136:151]
    ds_read_b128 v[152:155], v22 offset:40960
    s_waitcnt lgkmcnt(3)
    v_mfma_f32_32x32x16_bf16 v[136:151], v[76:79], v[156:159], v[136:151]
    ds_read_b128 v[156:159], v23 offset:40960
    s_waitcnt lgkmcnt(3)
    v_mfma_f32_32x32x16_bf16 v[136:151], v[80:83], v[160:163], v[136:151]
    ds_read_b128 v[160:163], v24 offset:40960
    s_waitcnt lgkmcnt(3)
    v_mfma_f32_32x32x16_bf16 v[136:151], v[84:87], v[164:167], v[136:151]
    ds_read_b128 v[164:167], v25 offset:40960
    s_waitcnt lgkmcnt(3)
    v_mfma_f32_32x32x16_bf16 v[136:151], v[88:91], v[152:155], v[136:151]
    s_waitcnt lgkmcnt(2)
    v_mfma_f32_32x32x16_bf16 v[136:151], v[92:95], v[156:159], v[136:151]
    s_waitcnt lgkmcnt(1)
    v_mfma_f32_32x32x16_bf16 v[136:151], v[96:99], v[160:163], v[136:151]
    s_waitcnt lgkmcnt(0)
    v_mfma_f32_32x32x16_bf16 v[136:151], v[100:103], v[164:167], v[136:151]
    s_branch L_gtr9
L_gt11:
    ds_read_b128 v[152:155], v22 offset:49152
    ds_read_b128 v[156:159], v23 offset:49152
    ds_read_b128 v[160:163], v24 offset:49152
    ds_read_b128 v[164:167], v25 offset:49152
    s_waitcnt lgkmcnt(3)
    v_mfma_f32_32x32x16_bf16 v[136:151], v[104:107], v[152:155], v[136:151]
    ds_read_b128 v[152:155], v22 offset:57344
    s_waitcnt lgkmcnt(3)
    v_mfma_f32_32x32x16_bf16 v[136:151], v[108:111], v[156:159], v[136:151]
    ds_read_b128 v[156:159], v23 offset:57344
    s_waitcnt lgkmcnt(3)
    v_mfma_f32_32x32x16_bf16 v[136:151], v[112:115], v[160:163], v[136:151]
    ds_read_b128 v[160:163], v24 offset:57344
    s_waitcnt lgkmcnt(3)
    v_mfma_f32_32x32x16_bf16 v[136:151], v[116:119], v[164:167], v[136:151]
    ds_read_b128 v[164:167], v25 offset:57344
    s_waitcnt lgkmcnt(3)
    v_mfma_f32_32x32x16_bf16 v[136:151], v[120:123], v[152:155], v[136:151]
    s_waitcnt lgkmcnt(2)
    v_mfma_f32_32x32x16_bf16 v[136:151], v[124:127], v[156:159], v[136:151]
    s_waitcnt lgkmcnt(1)
    v_mfma_f32_32x32x16_bf16 v[136:151], v[128:131], v[160:163], v[136:151]
    s_waitcnt lgkmcnt(0)
    v_mfma_f32_32x32x16_bf16 v[136:151], v[132:135], v[164:167], v[136:151]
    s_branch L_gtr11
L_gt12:
    s_lshl1_add_u32 s78, s5, s3
    s_lshl_b32 s78, s78, 7
    s_add_u32 s78, s78, 0xc00000
    s_mov_b32 s79, 0xbfb8aa3b
    s_nop 3
    v_mul_f32 v136, s79, v136
    v_exp_f32 v136, v136
    s_nop 0
    v_add_f32 v136, 1.0, v136
    v_rcp_f32 v136, v136
    s_nop 0
    buffer_store_dword v136, v13, s[16:19], s78 offen sc1
    s_branch L_gtr12
L_gt14:
    s_lshl_b32 s78, s5, 5
    s_add_u32 s78, s78, s3
    s_lshl_b32 s78, s78, 7
    s_add_u32 s78, s78, 0xd28f00
    v_mov_b32 v3, s70
    s_mov_b64 exec, 1
    buffer_store_dword v3, off, s[16:19], s78 sc1
    s_mov_b64 exec, -1
    s_branch L_gtr14
L_rt_3:
    s_sleep 1
    s_sub_u32 s83, s83, 1
    s_cbranch_scc0 L_gp_1
    s_mov_b32 s83, 0
    s_branch L_gpd_2
L_g_p0r:
L_gp_1:
    buffer_load_dword v6, v7, s[16:19], s76 offen sc1
    s_waitcnt vmcnt(0)
    v_cmp_ne_u32 vcc, s70, v6
    s_cbranch_vccnz L_rt_3
L_gpd_2:
    s_branch L_g_p0k
L_rt_6:
    s_sleep 8
    s_sub_u32 s83, s83, 1
    s_cbranch_scc0 L_gp_4
    s_mov_b32 s83, 0
    s_branch L_gpd_5
L_rt_9:
    s_sleep 4
    s_sub_u32 s83, s83, 1
    s_cbranch_scc0 L_gp_7
    s_mov_b32 s83, 0
    s_branch L_gpd_8
L_o_r0:
    s_waitcnt vmcnt(0)
    s_sub_u32 s83, s83, 1
    s_cbranch_scc1 L_o_x0
    s_sleep 3
    s_add_u32 s79, s75, 65536
    buffer_load_dwordx4 v[8:11], v2, s[16:19], s79 offen sc1
    buffer_load_dwordx4 v[12:15], v5, s[16:19], s79 offen sc1
    s_add_u32 s79, s75, 196608
    buffer_load_dwordx4 v[16:19], v2, s[16:19], s79 offen sc1
    buffer_load_dwordx4 v[20:23], v5, s[16:19], s79 offen sc1
    s_add_u32 s79, s75, 327680
    buffer_load_dwordx4 v[24:27], v2, s[16:19], s79 offen sc1
    buffer_load_dwordx4 v[28:31], v5, s[16:19], s79 offen sc1
    s_add_u32 s79, s75, 458752
    buffer_load_dwordx4 v[32:35], v2, s[16:19], s79 offen sc1
    buffer_load_dwordx4 v[36:39], v5, s[16:19], s79 offen sc1
    s_branch L_o_w0
L_o_x0:
    s_mov_b32 s83, 0
    s_branch L_o_k0
L_o_r1:
    s_waitcnt vmcnt(0)
    s_sub_u32 s83, s83, 1
    s_cbranch_scc1 L_o_x1
    s_sleep 3
    s_add_u32 s79, s75, 196608
    buffer_load_dwordx4 v[16:19], v2, s[16:19], s79 offen sc1
    buffer_load_dwordx4 v[20:23], v5, s[16:19], s79 offen sc1
    s_add_u32 s79, s75, 327680
    buffer_load_dwordx4 v[24:27], v2, s[16:19], s79 offen sc1
    buffer_load_dwordx4 v[28:31], v5, s[16:19], s79 offen sc1
    s_add_u32 s79, s75, 458752
    buffer_load_dwordx4 v[32:35], v2, s[16:19], s79 offen sc1
    buffer_load_dwordx4 v[36:39], v5, s[16:19], s79 offen sc1
    s_add_u32 s79, s75, 0
    buffer_load_dwordx4 v[8:11], v2, s[16:19], s79 offen sc1
    buffer_load_dwordx4 v[12:15], v5, s[16:19], s79 offen sc1
    s_branch L_o_w1
L_o_x1:
    s_mov_b32 s83, 0
    s_branch L_o_k1
L_o_r2:
    s_waitcnt vmcnt(0)
    s_sub_u32 s83, s83, 1
    s_cbranch_scc1 L_o_x2
    s_sleep 3
    s_add_u32 s79, s75, 327680
    buffer_load_dwordx4 v[24:27], v2, s[16:19], s79 offen sc1
    buffer_load_dwordx4 v[28:31], v5, s[16:19], s79 offen sc1
    s_add_u32 s79, s75, 458752
    buffer_load_dwordx4 v[32:35], v2, s[16:19], s79 offen sc1
    buffer_load_dwordx4 v[36:39], v5, s[16:19], s79 offen sc1
    s_add_u32 s79, s75, 0
    buffer_load_dwordx4 v[8:11], v2, s[16:19], s79 offen sc1
    buffer_load_dwordx4 v[12:15], v5, s[16:19], s79 offen sc1
    s_add_u32 s79, s75, 131072
    buffer_load_dwordx4 v[16:19], v2, s[16:19], s79 offen sc1
    buffer_load_dwordx4 v[20:23], v5, s[16:19], s79 offen sc1
    s_branch L_o_w2
L_o_x2:
    s_mov_b32 s83, 0
    s_branch L_o_k2
L_o_r3:
    s_waitcnt vmcnt(0)
    s_sub_u32 s83, s83, 1
    s_cbranch_scc1 L_o_x3
    s_sleep 3
    s_add_u32 s79, s75, 458752
    buffer_load_dwordx4 v[32:35], v2, s[16:19], s79 offen sc1
    buffer_load_dwordx4 v[36:39], v5, s[16:19], s79 offen sc1
    s_add_u32 s79, s75, 0
    buffer_load_dwordx4 v[8:11], v2, s[16:19], s79 offen sc1
    buffer_load_dwordx4 v[12:15], v5, s[16:19], s79 offen sc1
    s_add_u32 s79, s75, 131072
    buffer_load_dwordx4 v[16:19], v2, s[16:19], s79 offen sc1
    buffer_load_dwordx4 v[20:23], v5, s[16:19], s79 offen sc1
    s_add_u32 s79, s75, 262144
    buffer_load_dwordx4 v[24:27], v2, s[16:19], s79 offen sc1
    buffer_load_dwordx4 v[28:31], v5, s[16:19], s79 offen sc1
    s_branch L_o_w3
L_o_x3:
    s_mov_b32 s83, 0
    s_branch L_o_k3
L_o_r4:
    s_waitcnt vmcnt(0)
    s_sub_u32 s83, s83, 1
    s_cbranch_scc1 L_o_x4
    s_sleep 3
    s_add_u32 s79, s75, 0
    buffer_load_dwordx4 v[8:11], v2, s[16:19], s79 offen sc1
    buffer_load_dwordx4 v[12:15], v5, s[16:19], s79 offen sc1
    s_add_u32 s79, s75, 131072
    buffer_load_dwordx4 v[16:19], v2, s[16:19], s79 offen sc1
    buffer_load_dwordx4 v[20:23], v5, s[16:19], s79 offen sc1
    s_add_u32 s79, s75, 262144
    buffer_load_dwordx4 v[24:27], v2, s[16:19], s79 offen sc1
    buffer_load_dwordx4 v[28:31], v5, s[16:19], s79 offen sc1
    s_add_u32 s79, s75, 393216
    buffer_load_dwordx4 v[32:35], v2, s[16:19], s79 offen sc1
    buffer_load_dwordx4 v[36:39], v5, s[16:19], s79 offen sc1
    s_branch L_o_w4
L_o_x4:
    s_mov_b32 s83, 0
    s_branch L_o_k4
L_o_r5:
    s_waitcnt vmcnt(0)
    s_sub_u32 s83, s83, 1
    s_cbranch_scc1 L_o_x5
    s_sleep 3
    s_add_u32 s79, s75, 131072
    buffer_load_dwordx4 v[16:19], v2, s[16:19], s79 offen sc1
    buffer_load_dwordx4 v[20:23], v5, s[16:19], s79 offen sc1
    s_add_u32 s79, s75, 262144
    buffer_load_dwordx4 v[24:27], v2, s[16:19], s79 offen sc1
    buffer_load_dwordx4 v[28:31], v5, s[16:19], s79 offen sc1
    s_add_u32 s79, s75, 393216
    buffer_load_dwordx4 v[32:35], v2, s[16:19], s79 offen sc1
    buffer_load_dwordx4 v[36:39], v5, s[16:19], s79 offen sc1
    s_branch L_o_w5
L_o_x5:
    s_mov_b32 s83, 0
    s_branch L_o_k5
L_o_r6:
    s_waitcnt vmcnt(0)
    s_sub_u32 s83, s83, 1
    s_cbranch_scc1 L_o_x6
    s_sleep 3
    s_add_u32 s79, s75, 262144
    buffer_load_dwordx4 v[24:27], v2, s[16:19], s79 offen sc1
    buffer_load_dwordx4 v[28:31], v5, s[16:19], s79 offen sc1
    s_add_u32 s79, s75, 393216
    buffer_load_dwordx4 v[32:35], v2, s[16:19], s79 offen sc1
    buffer_load_dwordx4 v[36:39], v5, s[16:19], s79 offen sc1
    s_branch L_o_w6
L_o_x6:
    s_mov_b32 s83, 0
    s_branch L_o_k6
L_o_r7:
    s_waitcnt vmcnt(0)
    s_sub_u32 s83, s83, 1
    s_cbranch_scc1 L_o_x7
    s_sleep 3
    s_add_u32 s79, s75, 393216
    buffer_load_dwordx4 v[32:35], v2, s[16:19], s79 offen sc1
    buffer_load_dwordx4 v[36:39], v5, s[16:19], s79 offen sc1
    s_branch L_o_w7
L_o_x7:
    s_mov_b32 s83, 0
    s_branch L_o_k7
.p2align 6
L_awave:
    s_sub_u32 s3, s3, 4
    v_lshlrev_b32 v158, 7, v1
    s_cmp_lg_u32 s3, 0
    s_cbranch_scc1 L_a_nocode
    s_getpc_b64 s[40:41]
L_pc:
    s_sub_u32 s40, s40, L_pc-gated_mix__mha_block__glu_gated_glu__prompt_kernel
    s_subb_u32 s41, s41, 0
    s_mov_b32 s42, L_codeend-gated_mix__mha_block__glu_gated_glu__prompt_kernel
    s_mov_b32 s43, 0x20000
    s_lshr_b32 s76, s2, 3
    s_lshl_b32 s76, s76, 10
    s_mov_b64 exec, 0xff
    buffer_load_dword v157, v158, s[40:43], s76 offen
    s_mov_b64 exec, -1
L_a_nocode:
    s_bfe_u32 s71, s2, 0x20003
    s_lshr_b32 s7, s2, 5
    s_and_b32 s6, s2, 7
    s_lshl2_add_u32 s6, s6, s71
    v_mov_b32 v4, 162816
    v_mov_b32 v5, 1
    s_mov_b32 s83, 200000
    v_lshlrev_b32 v2, 4, v1
    s_bfe_u32 s73, s3, 0x10001
    s_and_b32 s74, s3, 1
    s_lshr_b32 s75, s3, 2
    v_and_b32 v15, 15, v1
    v_lshrrev_b32 v16, 4, v1
    v_bfe_u32 v7, v1, 1, 3
    v_xor_b32 v3, v16, v7
    v_lshlrev_b32 v3, 4, v3
    v_lshl_add_u32 v15, v15, 7, v3
    s_lshl_b32 s76, s73, 12
    v_add_u32 v14, s76, v15
    v_mov_b32 v8, v14
    v_bfe_u32 v3, v1, 2, 2
    v_lshlrev_b32 v15, 6, v3
    v_and_b32 v3, 3, v1
    v_lshl_add_u32 v15, v3, 3, v15
    v_bfe_u32 v3, v1, 4, 1
    v_lshl_add_u32 v7, v16, 10, v15
    v_lshl_add_u32 v7, v3, 5, v7
    s_lshl_b32 s76, s74, 9
    s_add_u32 s76, s76, 65536
    v_add_u32 v12, s76, v7
    v_lshl_add_u32 v15, v3, 9, v15
    v_lshrrev_b32 v16, 5, v1
    v_mul_u32_u24 v7, 6144, v16
    v_add_u32 v15, v15, v7
    s_mov_b32 s47, s72
    s_xor_b32 s72, s74, s75
    v_xor_b32 v7, s72, v3
    v_lshl_add_u32 v15, v7, 5, v15
    v_add_u32 v166, 65536, v15
    s_waitcnt lgkmcnt(0)
    s_add_u32 s44, s68, 0xdf0000
    s_addc_u32 s45, s69, 0
    s_load_dword s70, s[44:45], 0
    s_mov_b32 s16, s68
    s_mov_b32 s17, s69
    s_mov_b32 s18, 0x1000000
    s_mov_b32 s19, 0x20000
    s_add_u32 s20, s68, 0x1000000
    s_addc_u32 s21, s69, 0
    s_mov_b32 s22, 0x560000
    s_mov_b32 s23, 0x20000
    s_lshl1_add_u32 s48, s5, s73
    s_and_b32 s77, s3, 3
    s_lshl_b32 s76, s75, 15
    v_add_u32 v153, s76, v2
    v_and_b32 v3, 15, v1
    v_lshlrev_b32 v3, 4, v3
    v_lshrrev_b32 v7, 5, v1
    v_lshl_add_u32 v3, v7, 8, v3
    v_and_b32 v7, 27, v1
    v_cmp_eq_u32 vcc, 16, v7
    v_mov_b32 v16, 0x18000
    v_mov_b32 v15, 1024
    v_cndmask_b32 v16, v16, v15, vcc
    v_and_b32 v7, 16, v1
    v_cmp_eq_u32 vcc, 0, v7
    v_add_u32 v15, 512, v3
    s_mul_i32 s76, s75, 33280
    s_add_u32 s76, s76, 65536
    v_cndmask_b32 v154, v16, v3, vcc
    v_cndmask_b32 v155, v16, v15, vcc
    v_add_u32 v154, s76, v154
    v_add_u32 v155, s76, v155
    v_lshl_add_u32 v161, v7, 5, v3
    v_mov_b32 v152, 0xdddd
    v_and_b32 v159, 31, v1
    v_lshlrev_b32 v159, 2, v159
    v_mul_u32_u24 v160, 260, v159
    s_add_u32 s76, s76, 1024
    v_add_u32 v160, s76, v160
    s_lshl_b32 s76, s75, 2
    v_add_u32 v156, s76, v4
    v_and_b32 v3, 3, v1
    v_lshl_add_u32 v162, v3, 2, v4
    s_mul_i32 s79, s77, 2304
    s_lshl_b32 s80, s75, 15
    s_add_u32 s79, s79, s80
    v_add_u32 v163, s79, v2
    v_lshrrev_b32 v164, 2, v2
    v_add_u32 v164, s79, v164
    s_lshl_b32 s80, s3, 2
    v_add_u32 v165, s80, v4
    s_lshl_b32 s88, s7, 3
    s_lshl1_add_u32 s88, s77, s88
    s_add_u32 s88, s88, s75
    s_lshl_b32 s89, s6, 16
    s_lshl_b32 s90, s88, 10
    s_add_u32 s90, s90, s89
    s_xor_b32 s91, s90, 1024
    s_lshl_b32 s95, s75, 5
    s_add_u32 s95, s95, s77
    s_lshl_b32 s94, s95, 10
    s_mul_i32 s95, s95, 1040
    s_add_u32 s95, s95, 65536
    s_add_u32 s92, s89, s94
    s_add_u32 s92, s92, 0x200000
    s_add_u32 s93, s92, 0x200000
    s_lshl_b32 s96, s4, 5
    s_add_u32 s96, s96, s5
    s_lshl_b32 s96, s96, 7
    s_add_u32 s96, s96, 0xd00000
    s_bfe_u32 s101, s5, 0x10003
    s_lshl1_add_u32 s101, s4, s101
    s_and_b32 s78, s2, 3
    s_mov_b32 s100, 0x120c0600
    s_cmp_eq_u32 s78, 1
    s_cmov_b32 s100, 0x26211c17
    s_cmp_eq_u32 s78, 2
    s_cmov_b32 s100, 0x3c36302b
    s_cmp_eq_u32 s78, 3
    s_cmov_b32 s100, 0x514c4742
    s_lshl_b32 s78, s101, 3
    s_lshr_b32 s100, s100, s78
    s_and_b32 s100, s100, 0xff
    s_lshr_b32 s97, 0xe07, s101
    s_and_b32 s97, s97, 1
    s_xor_b32 s76, s100, s72
    s_and_b32 s76, s76, 1
    s_add_u32 s98, s100, s76
    s_xor_b32 s79, s76, 1
    s_or_b32 s97, s97, s79
    s_and_b32 s76, s76, s100
    s_lshl_b32 s76, s76, 10
    v_add_u32 v166, s76, v166
    s_lshl_b32 s76, s75, 3
    s_xor_b32 s76, s76, s5
    s_lshl_b32 s98, s98, 16
    s_lshl1_add_u32 s79, s76, s73
    s_lshl_b32 s79, s79, 10
    s_add_u32 s98, s98, s79
    s_lshl4_add_u32 s99, s76, s101
    s_lshl2_add_u32 s99, s99, s77
    s_lshl_b32 s99, s99, 7
    s_add_u32 s99, s99, 0xd88000
    s_lshl_b32 s49, s4, 2
    s_lshl1_add_u32 s49, s74, s49
    s_lshl_b32 s49, s49, 6
    s_add_u32 s49, s49, s48
    s_lshl_b32 s49, s49, 10
    s_mov_b32 s60, 0
    s_add_u32 s76, s47, 7
    s_and_b32 s76, s76, 3
    s_add_u32 s76, s76, 12
    s_sub_u32 s76, s76, s47
    s_and_b32 s76, s76, 7
    s_lshl4_add_u32 s60, s60, s76
    s_add_u32 s76, s47, 6
    s_and_b32 s76, s76, 3
    s_add_u32 s76, s76, 12
    s_sub_u32 s76, s76, s47
    s_and_b32 s76, s76, 7
    s_lshl4_add_u32 s60, s60, s76
    s_add_u32 s76, s47, 5
    s_and_b32 s76, s76, 3
    s_add_u32 s76, s76, 12
    s_sub_u32 s76, s76, s47
    s_and_b32 s76, s76, 7
    s_lshl4_add_u32 s60, s60, s76
    s_add_u32 s76, s47, 4
    s_and_b32 s76, s76, 3
    s_add_u32 s76, s76, 12
    s_sub_u32 s76, s76, s47
    s_and_b32 s76, s76, 7
    s_lshl4_add_u32 s60, s60, s76
    s_add_u32 s76, s47, 3
    s_and_b32 s76, s76, 3
    s_add_u32 s76, s76, 8
    s_sub_u32 s76, s76, s47
    s_and_b32 s76, s76, 7
    s_lshl4_add_u32 s60, s60, s76
    s_add_u32 s76, s47, 2
    s_and_b32 s76, s76, 3
    s_add_u32 s76, s76, 8
    s_sub_u32 s76, s76, s47
    s_and_b32 s76, s76, 7
    s_lshl4_add_u32 s60, s60, s76
    s_add_u32 s76, s47, 1
    s_and_b32 s76, s76, 3
    s_add_u32 s76, s76, 8
    s_sub_u32 s76, s76, s47
    s_and_b32 s76, s76, 7
    s_lshl4_add_u32 s60, s60, s76
    s_add_u32 s76, s47, 0
    s_and_b32 s76, s76, 3
    s_add_u32 s76, s76, 8
    s_sub_u32 s76, s76, s47
    s_and_b32 s76, s76, 7
    s_lshl4_add_u32 s60, s60, s76
    s_cmp_lg_u32 s75, 0
    s_cmov_b32 s60, 0xbdcbdcbd
    v_mov_b32 v16, 0
    v_mov_b32 v17, 0
    v_mov_b32 v18, 0
    v_mov_b32 v19, 0
    v_mov_b32 v20, 0
    v_mov_b32 v21, 0
    v_mov_b32 v22, 0
    v_mov_b32 v23, 0
    v_mov_b32 v24, 0
    v_mov_b32 v25, 0
    v_mov_b32 v26, 0
    v_mov_b32 v27, 0
    v_mov_b32 v28, 0
    v_mov_b32 v29, 0
    v_mov_b32 v30, 0
    v_mov_b32 v31, 0
    v_mov_b32 v32, 0
    v_mov_b32 v33, 0
    v_mov_b32 v34, 0
    v_mov_b32 v35, 0
    v_mov_b32 v36, 0
    v_mov_b32 v37, 0
    v_mov_b32 v38, 0
    v_mov_b32 v39, 0
    s_mov_b32 s79, 0
    s_mov_b32 s80, 0
    s_lshl_b32 s76, s75, 5
    v_xor_b32 v15, s76, v12
    s_xor_b32 s76, s75, 1
    s_lshl_b32 s76, s76, 13
    v_add_u32 v12, s76, v12
    v_add_u32 v13, s80, v12
    v_add_u32 v11, s80, v15
    v_xor_b32 v9, 64, v8
    v_xor_b32 v10, 32, v13
    s_cmp_eq_u32 s75, 0
    s_cselect_b32 s50, 1.0, 0x3eb8aa3b
    s_cselect_b32 s52, 0x200000, 0
    s_add_u32 s52, s52, s49
    s_add_u32 s53, s52, 0x10000
    s_lshl_b32 s54, s75, 16
    s_add_u32 s54, s54, s49
    s_add_u32 s54, s54, 0x400000
    s_barrier
    ds_read_b128 v[48:51], v8
    ds_read_b128 v[52:55], v8 offset:2048
    ds_read_b64_tr_b16 v[56:57], v13 offset:0
    ds_read_b64_tr_b16 v[58:59], v13 offset:256
    ds_read_b64_tr_b16 v[60:61], v10 offset:0
    ds_read_b64_tr_b16 v[62:63], v10 offset:256
    ds_read_b64_tr_b16 v[64:65], v11 offset:16384
    ds_read_b64_tr_b16 v[66:67], v11 offset:16640
    ds_read_b128 v[68:71], v9
    ds_read_b128 v[72:75], v9 offset:2048
    ds_read_b64_tr_b16 v[76:77], v13 offset:4096
    ds_read_b64_tr_b16 v[78:79], v13 offset:4352
    ds_read_b64_tr_b16 v[80:81], v10 offset:4096
    ds_read_b64_tr_b16 v[82:83], v10 offset:4352
    ds_read_b64_tr_b16 v[84:85], v11 offset:20480
    ds_read_b64_tr_b16 v[86:87], v11 offset:20736
    s_add_u32 s80, s80, 24576
    s_cmp_eq_u32 s80, 98304
    s_cmov_b32 s80, 0
    v_add_u32 v8, 8192, v8
    v_add_u32 v13, s80, v12
    v_add_u32 v11, s80, v15
    v_xor_b32 v9, 64, v8
    v_xor_b32 v10, 32, v13
    s_waitcnt lgkmcnt(0)
    s_barrier
    v_mfma_f32_16x16x32_bf16 v[16:19], v[56:59], v[48:51], v[16:19]
    ds_read_b128 v[96:99], v8
    ds_read_b128 v[100:103], v8 offset:2048
    v_mfma_f32_16x16x32_bf16 v[20:23], v[56:59], v[52:55], v[20:23]
    ds_read_b64_tr_b16 v[104:105], v13 offset:0
    ds_read_b64_tr_b16 v[106:107], v13 offset:256
    v_mfma_f32_16x16x32_bf16 v[24:27], v[60:63], v[48:51], v[24:27]
    ds_read_b64_tr_b16 v[108:109], v10 offset:0
    ds_read_b64_tr_b16 v[110:111], v10 offset:256
    ds_read_b64_tr_b16 v[112:113], v11 offset:16384
    v_mfma_f32_16x16x32_bf16 v[28:31], v[60:63], v[52:55], v[28:31]
    ds_read_b64_tr_b16 v[114:115], v11 offset:16640
    ds_read_b128 v[116:119], v9
    v_mfma_f32_16x16x32_bf16 v[32:35], v[48:51], v[64:67], v[32:35]
    ds_read_b128 v[120:123], v9 offset:2048
    ds_read_b64_tr_b16 v[124:125], v13 offset:4096
    ds_read_b64_tr_b16 v[126:127], v13 offset:4352
    v_mfma_f32_16x16x32_bf16 v[36:39], v[52:55], v[64:67], v[36:39]
    ds_read_b64_tr_b16 v[128:129], v10 offset:4096
    ds_read_b64_tr_b16 v[130:131], v10 offset:4352
    v_mfma_f32_16x16x32_bf16 v[16:19], v[76:79], v[68:71], v[16:19]
    ds_read_b64_tr_b16 v[132:133], v11 offset:20480
    ds_read_b64_tr_b16 v[134:135], v11 offset:20736
    v_mfma_f32_16x16x32_bf16 v[20:23], v[76:79], v[72:75], v[20:23]
    s_add_u32 s80, s80, 24576
    s_cmp_eq_u32 s80, 98304
    s_cmov_b32 s80, 0
    v_mfma_f32_16x16x32_bf16 v[24:27], v[80:83], v[68:71], v[24:27]
    v_add_u32 v8, 8192, v8
    v_add_u32 v13, s80, v12
    v_mfma_f32_16x16x32_bf16 v[28:31], v[80:83], v[72:75], v[28:31]
    v_add_u32 v11, s80, v15
    v_xor_b32 v9, 64, v8
    v_xor_b32 v10, 32, v13
    v_mfma_f32_16x16x32_bf16 v[32:35], v[68:71], v[84:87], v[32:35]
    v_mfma_f32_16x16x32_bf16 v[36:39], v[72:75], v[84:87], v[36:39]
    s_waitcnt lgkmcnt(12)
    v_mfma_f32_16x16x32_bf16 v[16:19], v[104:107], v[96:99], v[16:19]
    v_mfma_f32_16x16x32_bf16 v[20:23], v[104:107], v[100:103], v[20:23]
    s_waitcnt lgkmcnt(10)
    v_mfma_f32_16x16x32_bf16 v[24:27], v[108:111], v[96:99], v[24:27]
    v_mfma_f32_16x16x32_bf16 v[28:31], v[108:111], v[100:103], v[28:31]
    s_waitcnt lgkmcnt(8)
    v_mfma_f32_16x16x32_bf16 v[32:35], v[96:99], v[112:115], v[32:35]
    v_mfma_f32_16x16x32_bf16 v[36:39], v[100:103], v[112:115], v[36:39]
    s_waitcnt lgkmcnt(4)
    v_mfma_f32_16x16x32_bf16 v[16:19], v[124:127], v[116:119], v[16:19]
    v_mfma_f32_16x16x32_bf16 v[20:23], v[124:127], v[120:123], v[20:23]
    s_waitcnt lgkmcnt(2)
    v_mfma_f32_16x16x32_bf16 v[24:27], v[128:131], v[116:119], v[24:27]
    v_mfma_f32_16x16x32_bf16 v[28:31], v[128:131], v[120:123], v[28:31]
    s_waitcnt lgkmcnt(0)
    v_mfma_f32_16x16x32_bf16 v[32:35], v[116:119], v[132:135], v[32:35]
    v_mfma_f32_16x16x32_bf16 v[36:39], v[120:123], v[132:135], v[36:39]
    s_barrier
    ds_read_b128 v[48:51], v8
    ds_read_b128 v[52:55], v8 offset:2048
    ds_read_b64_tr_b16 v[56:57], v13 offset:0
    ds_read_b64_tr_b16 v[58:59], v13 offset:256
    ds_read_b64_tr_b16 v[60:61], v10 offset:0
    ds_read_b64_tr_b16 v[62:63], v10 offset:256
    ds_read_b64_tr_b16 v[64:65], v11 offset:16384
    ds_read_b64_tr_b16 v[66:67], v11 offset:16640
    ds_read_b128 v[68:71], v9
    ds_read_b128 v[72:75], v9 offset:2048
    ds_read_b64_tr_b16 v[76:77], v13 offset:4096
    ds_read_b64_tr_b16 v[78:79], v13 offset:4352
    ds_read_b64_tr_b16 v[80:81], v10 offset:4096
    ds_read_b64_tr_b16 v[82:83], v10 offset:4352
    ds_read_b64_tr_b16 v[84:85], v11 offset:20480
    ds_read_b64_tr_b16 v[86:87], v11 offset:20736
    s_add_u32 s80, s80, 24576
    s_cmp_eq_u32 s80, 98304
    s_cmov_b32 s80, 0
    v_add_u32 v8, 8192, v8
    v_add_u32 v13, s80, v12
    v_add_u32 v11, s80, v15
    v_xor_b32 v9, 64, v8
    v_xor_b32 v10, 32, v13
    s_mov_b32 s79, 2
    s_branch L_p1_in
L_p1:
    v_mfma_f32_16x16x32_bf16 v[32:35], v[116:119], v[132:135], v[32:35]
    v_mfma_f32_16x16x32_bf16 v[36:39], v[120:123], v[132:135], v[36:39]
L_p1_in:
    s_waitcnt lgkmcnt(0)
    s_barrier
    v_mfma_f32_16x16x32_bf16 v[16:19], v[56:59], v[48:51], v[16:19]
    ds_read_b128 v[96:99], v8
    ds_read_b128 v[100:103], v8 offset:2048
    v_mfma_f32_16x16x32_bf16 v[20:23], v[56:59], v[52:55], v[20:23]
    ds_read_b64_tr_b16 v[104:105], v13 offset:0
    ds_read_b64_tr_b16 v[106:107], v13 offset:256
    v_mfma_f32_16x16x32_bf16 v[24:27], v[60:63], v[48:51], v[24:27]
    ds_read_b64_tr_b16 v[108:109], v10 offset:0
    ds_read_b64_tr_b16 v[110:111], v10 offset:256
    ds_read_b64_tr_b16 v[112:113], v11 offset:16384
    v_mfma_f32_16x16x32_bf16 v[28:31], v[60:63], v[52:55], v[28:31]
    ds_read_b64_tr_b16 v[114:115], v11 offset:16640
    ds_read_b128 v[116:119], v9
    v_mfma_f32_16x16x32_bf16 v[32:35], v[48:51], v[64:67], v[32:35]
    ds_read_b128 v[120:123], v9 offset:2048
    ds_read_b64_tr_b16 v[124:125], v13 offset:4096
    ds_read_b64_tr_b16 v[126:127], v13 offset:4352
    v_mfma_f32_16x16x32_bf16 v[36:39], v[52:55], v[64:67], v[36:39]
    ds_read_b64_tr_b16 v[128:129], v10 offset:4096
    ds_read_b64_tr_b16 v[130:131], v10 offset:4352
    v_mfma_f32_16x16x32_bf16 v[16:19], v[76:79], v[68:71], v[16:19]
    ds_read_b64_tr_b16 v[132:133], v11 offset:20480
    ds_read_b64_tr_b16 v[134:135], v11 offset:20736
    v_mfma_f32_16x16x32_bf16 v[20:23], v[76:79], v[72:75], v[20:23]
    s_add_u32 s80, s80, 24576
    s_cmp_eq_u32 s80, 98304
    s_cmov_b32 s80, 0
    v_mfma_f32_16x16x32_bf16 v[24:27], v[80:83], v[68:71], v[24:27]
    v_add_u32 v8, 8192, v8
    v_add_u32 v13, s80, v12
    v_mfma_f32_16x16x32_bf16 v[28:31], v[80:83], v[72:75], v[28:31]
    v_add_u32 v11, s80, v15
    v_xor_b32 v9, 64, v8
    v_xor_b32 v10, 32, v13
    s_cmp_eq_u32 s79, 6
    s_cbranch_scc1 L_p1_e
    v_mfma_f32_16x16x32_bf16 v[32:35], v[68:71], v[84:87], v[32:35]
    v_mfma_f32_16x16x32_bf16 v[36:39], v[72:75], v[84:87], v[36:39]
L_p1_in2:
    s_waitcnt lgkmcnt(0)
    s_barrier
    s_add_u32 s79, s79, 2
    v_mfma_f32_16x16x32_bf16 v[16:19], v[104:107], v[96:99], v[16:19]
    ds_read_b128 v[48:51], v8
    ds_read_b128 v[52:55], v8 offset:2048
    v_mfma_f32_16x16x32_bf16 v[20:23], v[104:107], v[100:103], v[20:23]
    ds_read_b64_tr_b16 v[56:57], v13 offset:0
    ds_read_b64_tr_b16 v[58:59], v13 offset:256
    v_mfma_f32_16x16x32_bf16 v[24:27], v[108:111], v[96:99], v[24:27]
    ds_read_b64_tr_b16 v[60:61], v10 offset:0
    ds_read_b64_tr_b16 v[62:63], v10 offset:256
    ds_read_b64_tr_b16 v[64:65], v11 offset:16384
    v_mfma_f32_16x16x32_bf16 v[28:31], v[108:111], v[100:103], v[28:31]
    ds_read_b64_tr_b16 v[66:67], v11 offset:16640
    ds_read_b128 v[68:71], v9
    v_mfma_f32_16x16x32_bf16 v[32:35], v[96:99], v[112:115], v[32:35]
    ds_read_b128 v[72:75], v9 offset:2048
    ds_read_b64_tr_b16 v[76:77], v13 offset:4096
    ds_read_b64_tr_b16 v[78:79], v13 offset:4352
    v_mfma_f32_16x16x32_bf16 v[36:39], v[100:103], v[112:115], v[36:39]
    ds_read_b64_tr_b16 v[80:81], v10 offset:4096
    ds_read_b64_tr_b16 v[82:83], v10 offset:4352
    v_mfma_f32_16x16x32_bf16 v[16:19], v[124:127], v[116:119], v[16:19]
    ds_read_b64_tr_b16 v[84:85], v11 offset:20480
    ds_read_b64_tr_b16 v[86:87], v11 offset:20736
    v_mfma_f32_16x16x32_bf16 v[20:23], v[124:127], v[120:123], v[20:23]
    s_add_u32 s80, s80, 24576
    s_cmp_eq_u32 s80, 98304
    s_cmov_b32 s80, 0
    v_mfma_f32_16x16x32_bf16 v[24:27], v[128:131], v[116:119], v[24:27]
    v_add_u32 v8, 8192, v8
    v_add_u32 v13, s80, v12
    v_mfma_f32_16x16x32_bf16 v[28:31], v[128:131], v[120:123], v[28:31]
    v_add_u32 v11, s80, v15
    v_xor_b32 v9, 64, v8
    v_xor_b32 v10, 32, v13
    s_branch L_p1
L_p1_e:
    v_mfma_f32_16x16x32_bf16 v[32:35], v[68:71], v[84:87], v[32:35]
    v_mfma_f32_16x16x32_bf16 v[36:39], v[72:75], v[84:87], v[36:39]
    s_waitcnt lgkmcnt(12)
    v_mfma_f32_16x16x32_bf16 v[16:19], v[104:107], v[96:99], v[16:19]
    v_mfma_f32_16x16x32_bf16 v[20:23], v[104:107], v[100:103], v[20:23]
    s_waitcnt lgkmcnt(10)
    v_mfma_f32_16x16x32_bf16 v[24:27], v[108:111], v[96:99], v[24:27]
    v_mfma_f32_16x16x32_bf16 v[28:31], v[108:111], v[100:103], v[28:31]
    s_waitcnt lgkmcnt(8)
    v_mfma_f32_16x16x32_bf16 v[32:35], v[96:99], v[112:115], v[32:35]
    v_mfma_f32_16x16x32_bf16 v[36:39], v[100:103], v[112:115], v[36:39]
    s_waitcnt lgkmcnt(4)
    v_mfma_f32_16x16x32_bf16 v[16:19], v[124:127], v[116:119], v[16:19]
    v_mfma_f32_16x16x32_bf16 v[20:23], v[124:127], v[120:123], v[20:23]
    s_waitcnt lgkmcnt(2)
    v_mfma_f32_16x16x32_bf16 v[24:27], v[128:131], v[116:119], v[24:27]
    v_mfma_f32_16x16x32_bf16 v[28:31], v[128:131], v[120:123], v[28:31]
    s_waitcnt lgkmcnt(0)
    v_mfma_f32_16x16x32_bf16 v[32:35], v[116:119], v[132:135], v[32:35]
    v_mfma_f32_16x16x32_bf16 v[36:39], v[120:123], v[132:135], v[36:39]
    s_add_u32 s70, s70, 1
    s_nop 1
    v_pk_mul_f32 v[16:17], v[16:17], s[50:51] op_sel_hi:[1,0]
    v_pk_mul_f32 v[18:19], v[18:19], s[50:51] op_sel_hi:[1,0]
    v_pk_mul_f32 v[20:21], v[20:21], s[50:51] op_sel_hi:[1,0]
    v_pk_mul_f32 v[22:23], v[22:23], s[50:51] op_sel_hi:[1,0]
    v_pk_mul_f32 v[24:25], v[24:25], s[50:51] op_sel_hi:[1,0]
    v_pk_mul_f32 v[26:27], v[26:27], s[50:51] op_sel_hi:[1,0]
    v_pk_mul_f32 v[28:29], v[28:29], s[50:51] op_sel_hi:[1,0]
    v_pk_mul_f32 v[30:31], v[30:31], s[50:51] op_sel_hi:[1,0]
    v_cvt_pk_bf16_f32 v16, v16, v17
    v_cvt_pk_bf16_f32 v17, v18, v19
    v_cvt_pk_bf16_f32 v18, v20, v21
    v_cvt_pk_bf16_f32 v19, v22, v23
    v_cvt_pk_bf16_f32 v20, v24, v25
    v_cvt_pk_bf16_f32 v21, v26, v27
    v_cvt_pk_bf16_f32 v22, v28, v29
    v_cvt_pk_bf16_f32 v23, v30, v31
    v_cvt_pk_bf16_f32 v24, v32, v33
    v_cvt_pk_bf16_f32 v25, v34, v35
    v_cvt_pk_bf16_f32 v26, v36, v37
    v_cvt_pk_bf16_f32 v27, v38, v39
    s_nop 1
    v_permlane16_swap_b32 v16, v18
    v_permlane16_swap_b32 v17, v19
    v_permlane16_swap_b32 v20, v22
    v_permlane16_swap_b32 v21, v23
    v_permlane16_swap_b32 v24, v26
    v_permlane16_swap_b32 v25, v27
    buffer_store_dwordx4 v[16:19], v2, s[16:19], s52 offen sc1
    buffer_store_dwordx4 v[20:23], v2, s[16:19], s53 offen sc1
    v_mov_b32 v36, 0
    v_mov_b32 v37, 0
    v_mov_b32 v38, 0
    v_mov_b32 v39, 0
    s_nop 1
    v_mfma_f32_32x32x16_bf16 v[104:119], v[36:39], v[36:39], 0
    v_mfma_f32_32x32x16_bf16 v[120:135], v[36:39], v[36:39], 0
    v_mfma_f32_32x32x16_bf16 v[136:151], v[36:39], v[36:39], 0
    s_mov_b32 s79, 0
    s_and_b32 s76, s60, 15
    s_lshl_b32 s76, s76, 13
    s_mov_b32 s56, 0
    s_mov_b32 s57, 49152
    s_mov_b32 s58, 73728
    s_cmp_eq_u32 s3, 7
    s_cselect_b32 s81, 2, -1
    v_add_u32 v8, s76, v14
    v_add_u32 v13, s56, v166
    s_cmp_eq_u32 s97, 0
    s_cbranch_scc1 L_g2
    s_barrier
    ds_read_b128 v[40:43], v8
    ds_read_b128 v[44:47], v8 offset:2048
    ds_read_b64_tr_b16 v[48:49], v13 offset:0
    ds_read_b64_tr_b16 v[50:51], v13 offset:256
    ds_read_b64_tr_b16 v[52:53], v13 offset:3072
    ds_read_b64_tr_b16 v[54:55], v13 offset:3328
    ds_read_b64_tr_b16 v[56:57], v13 offset:1024
    ds_read_b64_tr_b16 v[58:59], v13 offset:1280
    ds_read_b64_tr_b16 v[60:61], v13 offset:4096
    ds_read_b64_tr_b16 v[62:63], v13 offset:4352
    ds_read_b64_tr_b16 v[64:65], v13 offset:2048
    ds_read_b64_tr_b16 v[66:67], v13 offset:2304
    ds_read_b64_tr_b16 v[68:69], v13 offset:5120
    ds_read_b64_tr_b16 v[70:71], v13 offset:5376
    v_xor_b32 v8, 64, v8
    v_add_u32 v13, 12288, v13
    s_lshr_b32 s60, s60, 4
    s_and_b32 s76, s60, 15
    s_lshl_b32 s76, s76, 13
    s_mov_b32 s80, s56
    s_mov_b32 s56, s57
    s_mov_b32 s57, s58
    s_mov_b32 s58, s80
    s_branch L_g3l_in
L_g3l:
    v_mfma_f32_16x16x32_bf16 v[144:147], v[100:103], v[72:75], v[144:147]
    v_mfma_f32_16x16x32_bf16 v[148:151], v[100:103], v[76:79], v[148:151]
L_g3l_in:
    s_waitcnt lgkmcnt(0)
    v_mfma_f32_16x16x32_bf16 v[104:107], v[48:51], v[40:43], v[104:107]
    ds_read_b128 v[72:75], v8
    v_mfma_f32_16x16x32_bf16 v[108:111], v[48:51], v[44:47], v[108:111]
    ds_read_b128 v[76:79], v8 offset:2048
    ds_read_b64_tr_b16 v[80:81], v13 offset:0
    v_mfma_f32_16x16x32_bf16 v[112:115], v[52:55], v[40:43], v[112:115]
    ds_read_b64_tr_b16 v[82:83], v13 offset:256
    v_mfma_f32_16x16x32_bf16 v[116:119], v[52:55], v[44:47], v[116:119]
    ds_read_b64_tr_b16 v[84:85], v13 offset:3072
    ds_read_b64_tr_b16 v[86:87], v13 offset:3328
    v_mfma_f32_16x16x32_bf16 v[120:123], v[56:59], v[40:43], v[120:123]
    ds_read_b64_tr_b16 v[88:89], v13 offset:1024
    ds_read_b64_tr_b16 v[90:91], v13 offset:1280
    v_mfma_f32_16x16x32_bf16 v[124:127], v[56:59], v[44:47], v[124:127]
    ds_read_b64_tr_b16 v[92:93], v13 offset:4096
    v_mfma_f32_16x16x32_bf16 v[128:131], v[60:63], v[40:43], v[128:131]
    ds_read_b64_tr_b16 v[94:95], v13 offset:4352
    ds_read_b64_tr_b16 v[96:97], v13 offset:2048
    v_mfma_f32_16x16x32_bf16 v[132:135], v[60:63], v[44:47], v[132:135]
    ds_read_b64_tr_b16 v[98:99], v13 offset:2304
    v_mfma_f32_16x16x32_bf16 v[136:139], v[64:67], v[40:43], v[136:139]
    ds_read_b64_tr_b16 v[100:101], v13 offset:5120
    ds_read_b64_tr_b16 v[102:103], v13 offset:5376
    v_mfma_f32_16x16x32_bf16 v[140:143], v[64:67], v[44:47], v[140:143]
    v_add_u32 v8, s76, v14
    v_add_u32 v13, s56, v166
    s_cmp_eq_u32 s79, 14
    s_cbranch_scc1 L_g3l_e
    s_bitcmp1_b32 4101, s79
    v_mfma_f32_16x16x32_bf16 v[144:147], v[68:71], v[40:43], v[144:147]
    v_mfma_f32_16x16x32_bf16 v[148:151], v[68:71], v[44:47], v[148:151]
    s_waitcnt lgkmcnt(0)
    s_cbranch_scc1 L_g3l_d
    s_barrier
L_g3l_r:
    s_add_u32 s79, s79, 2
    v_mfma_f32_16x16x32_bf16 v[104:107], v[80:83], v[72:75], v[104:107]
    ds_read_b128 v[40:43], v8
    ds_read_b128 v[44:47], v8 offset:2048
    v_mfma_f32_16x16x32_bf16 v[108:111], v[80:83], v[76:79], v[108:111]
    ds_read_b64_tr_b16 v[48:49], v13 offset:0
    ds_read_b64_tr_b16 v[50:51], v13 offset:256
    v_mfma_f32_16x16x32_bf16 v[112:115], v[84:87], v[72:75], v[112:115]
    ds_read_b64_tr_b16 v[52:53], v13 offset:3072
    ds_read_b64_tr_b16 v[54:55], v13 offset:3328
    v_mfma_f32_16x16x32_bf16 v[116:119], v[84:87], v[76:79], v[116:119]
    ds_read_b64_tr_b16 v[56:57], v13 offset:1024
    ds_read_b64_tr_b16 v[58:59], v13 offset:1280
    ds_read_b64_tr_b16 v[60:61], v13 offset:4096
    v_mfma_f32_16x16x32_bf16 v[120:123], v[88:91], v[72:75], v[120:123]
    ds_read_b64_tr_b16 v[62:63], v13 offset:4352
    ds_read_b64_tr_b16 v[64:65], v13 offset:2048
    v_mfma_f32_16x16x32_bf16 v[124:127], v[88:91], v[76:79], v[124:127]
    ds_read_b64_tr_b16 v[66:67], v13 offset:2304
    ds_read_b64_tr_b16 v[68:69], v13 offset:5120
    v_mfma_f32_16x16x32_bf16 v[128:131], v[92:95], v[72:75], v[128:131]
    ds_read_b64_tr_b16 v[70:71], v13 offset:5376
    v_xor_b32 v8, 64, v8
    v_add_u32 v13, 12288, v13
    v_mfma_f32_16x16x32_bf16 v[132:135], v[92:95], v[76:79], v[132:135]
    s_lshr_b32 s60, s60, 4
    s_and_b32 s76, s60, 15
    v_mfma_f32_16x16x32_bf16 v[136:139], v[96:99], v[72:75], v[136:139]
    s_lshl_b32 s76, s76, 13
    s_mov_b32 s80, s56
    v_mfma_f32_16x16x32_bf16 v[140:143], v[96:99], v[76:79], v[140:143]
    s_mov_b32 s56, s57
    s_mov_b32 s57, s58
    s_mov_b32 s58, s80
    s_branch L_g3l
L_g3l_d:
    s_cmp_eq_u32 s79, 2
    s_cbranch_scc1 L_g3l_f
    s_barrier
    s_cmp_eq_u32 s79, 0
    s_cbranch_scc0 L_g3l_s0
    s_setprio 3
    buffer_store_dwordx4 v[24:27], v161, s[16:19], s54 offen sc1
    s_setprio 0
    s_branch L_g3l_r
L_g3l_s0:
    s_cmp_eq_u32 s79, 12
    s_cbranch_scc0 L_g3l_s12
    s_setprio 3
    buffer_load_dwordx4 v[16:19], v2, s[16:19], s90 offen sc1
    buffer_load_dwordx4 v[20:23], v2, s[16:19], s91 offen sc1
    s_setprio 0
    s_branch L_g3l_r
L_g3l_s12:
    s_branch L_g3l_r
L_g3l_f:
    s_waitcnt vmcnt(0)
    s_cmp_eq_u32 s79, s81
    s_barrier
    s_cbranch_scc0 L_g3l_r
    v_mov_b32 v3, s70
    s_mov_b64 exec, 1
    buffer_store_dword v3, off, s[16:19], s96 sc1
    s_mov_b64 exec, -1
    s_branch L_g3l_r
L_g3l_e:
    v_mfma_f32_16x16x32_bf16 v[144:147], v[68:71], v[40:43], v[144:147]
    v_mfma_f32_16x16x32_bf16 v[148:151], v[68:71], v[44:47], v[148:151]
    s_waitcnt lgkmcnt(10)
    v_mfma_f32_16x16x32_bf16 v[104:107], v[80:83], v[72:75], v[104:107]
    v_mfma_f32_16x16x32_bf16 v[108:111], v[80:83], v[76:79], v[108:111]
    s_waitcnt lgkmcnt(8)
    v_mfma_f32_16x16x32_bf16 v[112:115], v[84:87], v[72:75], v[112:115]
    v_mfma_f32_16x16x32_bf16 v[116:119], v[84:87], v[76:79], v[116:119]
    s_waitcnt lgkmcnt(6)
    v_mfma_f32_16x16x32_bf16 v[120:123], v[88:91], v[72:75], v[120:123]
    v_mfma_f32_16x16x32_bf16 v[124:127], v[88:91], v[76:79], v[124:127]
    s_waitcnt lgkmcnt(4)
    v_mfma_f32_16x16x32_bf16 v[128:131], v[92:95], v[72:75], v[128:131]
    v_mfma_f32_16x16x32_bf16 v[132:135], v[92:95], v[76:79], v[132:135]
    s_waitcnt lgkmcnt(2)
    v_mfma_f32_16x16x32_bf16 v[136:139], v[96:99], v[72:75], v[136:139]
    v_mfma_f32_16x16x32_bf16 v[140:143], v[96:99], v[76:79], v[140:143]
    s_waitcnt lgkmcnt(0)
    v_mfma_f32_16x16x32_bf16 v[144:147], v[100:103], v[72:75], v[144:147]
    v_mfma_f32_16x16x32_bf16 v[148:151], v[100:103], v[76:79], v[148:151]
    s_branch L_gdone
L_g2:
    s_barrier
    ds_read_b128 v[40:43], v8
    ds_read_b128 v[44:47], v8 offset:2048
    ds_read_b64_tr_b16 v[48:49], v13 offset:0
    ds_read_b64_tr_b16 v[50:51], v13 offset:256
    ds_read_b64_tr_b16 v[52:53], v13 offset:3072
    ds_read_b64_tr_b16 v[54:55], v13 offset:3328
    ds_read_b64_tr_b16 v[56:57], v13 offset:1024
    ds_read_b64_tr_b16 v[58:59], v13 offset:1280
    ds_read_b64_tr_b16 v[60:61], v13 offset:4096
    ds_read_b64_tr_b16 v[62:63], v13 offset:4352
    v_xor_b32 v8, 64, v8
    v_add_u32 v13, 12288, v13
    s_lshr_b32 s60, s60, 4
    s_and_b32 s76, s60, 15
    s_lshl_b32 s76, s76, 13
    s_mov_b32 s80, s56
    s_mov_b32 s56, s57
    s_mov_b32 s57, s58
    s_mov_b32 s58, s80
    s_branch L_g2l_in
L_g2l:
    v_mfma_f32_16x16x32_bf16 v[128:131], v[92:95], v[72:75], v[128:131]
    v_mfma_f32_16x16x32_bf16 v[132:135], v[92:95], v[76:79], v[132:135]
L_g2l_in:
    s_waitcnt lgkmcnt(0)
    v_mfma_f32_16x16x32_bf16 v[104:107], v[48:51], v[40:43], v[104:107]
    ds_read_b128 v[72:75], v8
    ds_read_b128 v[76:79], v8 offset:2048
    v_mfma_f32_16x16x32_bf16 v[108:111], v[48:51], v[44:47], v[108:111]
    ds_read_b64_tr_b16 v[80:81], v13 offset:0
    ds_read_b64_tr_b16 v[82:83], v13 offset:256
    v_mfma_f32_16x16x32_bf16 v[112:115], v[52:55], v[40:43], v[112:115]
    ds_read_b64_tr_b16 v[84:85], v13 offset:3072
    ds_read_b64_tr_b16 v[86:87], v13 offset:3328
    v_mfma_f32_16x16x32_bf16 v[116:119], v[52:55], v[44:47], v[116:119]
    ds_read_b64_tr_b16 v[88:89], v13 offset:1024
    ds_read_b64_tr_b16 v[90:91], v13 offset:1280
    v_mfma_f32_16x16x32_bf16 v[120:123], v[56:59], v[40:43], v[120:123]
    ds_read_b64_tr_b16 v[92:93], v13 offset:4096
    ds_read_b64_tr_b16 v[94:95], v13 offset:4352
    v_mfma_f32_16x16x32_bf16 v[124:127], v[56:59], v[44:47], v[124:127]
    v_add_u32 v8, s76, v14
    v_add_u32 v13, s56, v166
    s_cmp_eq_u32 s79, 14
    s_cbranch_scc1 L_g2l_e
    s_bitcmp1_b32 4101, s79
    v_mfma_f32_16x16x32_bf16 v[128:131], v[60:63], v[40:43], v[128:131]
    v_mfma_f32_16x16x32_bf16 v[132:135], v[60:63], v[44:47], v[132:135]
    s_waitcnt lgkmcnt(0)
    s_cbranch_scc1 L_g2l_d
    s_barrier
L_g2l_r:
    s_add_u32 s79, s79, 2
    v_mfma_f32_16x16x32_bf16 v[104:107], v[80:83], v[72:75], v[104:107]
    ds_read_b128 v[40:43], v8
    ds_read_b128 v[44:47], v8 offset:2048
    ds_read_b64_tr_b16 v[48:49], v13 offset:0
    v_mfma_f32_16x16x32_bf16 v[108:111], v[80:83], v[76:79], v[108:111]
    ds_read_b64_tr_b16 v[50:51], v13 offset:256
    ds_read_b64_tr_b16 v[52:53], v13 offset:3072
    ds_read_b64_tr_b16 v[54:55], v13 offset:3328
    v_mfma_f32_16x16x32_bf16 v[112:115], v[84:87], v[72:75], v[112:115]
    ds_read_b64_tr_b16 v[56:57], v13 offset:1024
    ds_read_b64_tr_b16 v[58:59], v13 offset:1280
    ds_read_b64_tr_b16 v[60:61], v13 offset:4096
    v_mfma_f32_16x16x32_bf16 v[116:119], v[84:87], v[76:79], v[116:119]
    ds_read_b64_tr_b16 v[62:63], v13 offset:4352
    v_xor_b32 v8, 64, v8
    v_add_u32 v13, 12288, v13
    v_mfma_f32_16x16x32_bf16 v[120:123], v[88:91], v[72:75], v[120:123]
    s_lshr_b32 s60, s60, 4
    s_and_b32 s76, s60, 15
    s_lshl_b32 s76, s76, 13
    v_mfma_f32_16x16x32_bf16 v[124:127], v[88:91], v[76:79], v[124:127]
    s_mov_b32 s80, s56
    s_mov_b32 s56, s57
    s_mov_b32 s57, s58
    s_mov_b32 s58, s80
    s_branch L_g2l
L_g2l_d:
    s_cmp_eq_u32 s79, 2
    s_cbranch_scc1 L_g2l_f
    s_barrier
    s_cmp_eq_u32 s79, 0
    s_cbranch_scc0 L_g2l_s0
    s_setprio 3
    buffer_store_dwordx4 v[24:27], v161, s[16:19], s54 offen sc1
    s_setprio 0
    s_branch L_g2l_r
L_g2l_s0:
    s_cmp_eq_u32 s79, 12
    s_cbranch_scc0 L_g2l_s12
    s_setprio 3
    buffer_load_dwordx4 v[16:19], v2, s[16:19], s90 offen sc1
    buffer_load_dwordx4 v[20:23], v2, s[16:19], s91 offen sc1
    s_setprio 0
    s_branch L_g2l_r
L_g2l_s12:
    s_branch L_g2l_r
L_g2l_f:
    s_waitcnt vmcnt(0)
    s_cmp_eq_u32 s79, s81
    s_barrier
    s_cbranch_scc0 L_g2l_r
    v_mov_b32 v3, s70
    s_mov_b64 exec, 1
    buffer_store_dword v3, off, s[16:19], s96 sc1
    s_mov_b64 exec, -1
    s_branch L_g2l_r
L_g2l_e:
    v_mfma_f32_16x16x32_bf16 v[128:131], v[60:63], v[40:43], v[128:131]
    v_mfma_f32_16x16x32_bf16 v[132:135], v[60:63], v[44:47], v[132:135]
    s_waitcnt lgkmcnt(6)
    v_mfma_f32_16x16x32_bf16 v[104:107], v[80:83], v[72:75], v[104:107]
    v_mfma_f32_16x16x32_bf16 v[108:111], v[80:83], v[76:79], v[108:111]
    s_waitcnt lgkmcnt(4)
    v_mfma_f32_16x16x32_bf16 v[112:115], v[84:87], v[72:75], v[112:115]
    v_mfma_f32_16x16x32_bf16 v[116:119], v[84:87], v[76:79], v[116:119]
    s_waitcnt lgkmcnt(2)
    v_mfma_f32_16x16x32_bf16 v[120:123], v[88:91], v[72:75], v[120:123]
    v_mfma_f32_16x16x32_bf16 v[124:127], v[88:91], v[76:79], v[124:127]
    s_waitcnt lgkmcnt(0)
    v_mfma_f32_16x16x32_bf16 v[128:131], v[92:95], v[72:75], v[128:131]
    v_mfma_f32_16x16x32_bf16 v[132:135], v[92:95], v[76:79], v[132:135]
L_gdone:
    s_setprio 3
    s_barrier
    v_mov_b32 v24, 0x3f803f80
    v_mov_b32 v25, 0x3f803f80
    v_mov_b32 v26, 0x3f803f80
    v_mov_b32 v27, 0x3f803f80
    v_mov_b32 v28, 0
    v_mov_b32 v29, 0
    v_mov_b32 v30, 0
    v_mov_b32 v31, 0
    ds_write_b128 v160, v[24:27]
    v_add_u32 v3, v159, v4
    ds_write_b32 v3, v28
    s_mov_b32 s80, 0xbfb8aa3b
    v_mfma_f32_32x32x16_bf16 v[48:63], v[28:31], v[28:31], 0
    v_mfma_f32_32x32x16_bf16 v[64:79], v[28:31], v[28:31], 0
    v_mfma_f32_32x32x16_bf16 v[80:95], v[28:31], v[28:31], 0
    v_pk_mul_f32 v[104:105], v[104:105], s[80:81] op_sel_hi:[1,0]
    v_pk_mul_f32 v[106:107], v[106:107], s[80:81] op_sel_hi:[1,0]
    v_pk_mul_f32 v[108:109], v[108:109], s[80:81] op_sel_hi:[1,0]
    v_pk_mul_f32 v[110:111], v[110:111], s[80:81] op_sel_hi:[1,0]
    v_exp_f32 v104, v104
    v_exp_f32 v105, v105
    v_exp_f32 v106, v106
    v_exp_f32 v107, v107
    v_exp_f32 v108, v108
    v_exp_f32 v109, v109
    v_exp_f32 v110, v110
    v_exp_f32 v111, v111
    v_pk_add_f32 v[104:105], v[104:105], 1.0 op_sel_hi:[1,0]
    v_pk_add_f32 v[106:107], v[106:107], 1.0 op_sel_hi:[1,0]
    v_pk_add_f32 v[108:109], v[108:109], 1.0 op_sel_hi:[1,0]
    v_pk_add_f32 v[110:111], v[110:111], 1.0 op_sel_hi:[1,0]
    v_rcp_f32 v104, v104
    v_rcp_f32 v105, v105
    v_rcp_f32 v106, v106
    v_rcp_f32 v107, v107
    v_rcp_f32 v108, v108
    v_rcp_f32 v109, v109
    v_rcp_f32 v110, v110
    v_rcp_f32 v111, v111
    v_pk_mul_f32 v[104:105], v[104:105], v[112:113]
    v_pk_mul_f32 v[106:107], v[106:107], v[114:115]
    v_pk_mul_f32 v[108:109], v[108:109], v[116:117]
    v_pk_mul_f32 v[110:111], v[110:111], v[118:119]
    v_cvt_pk_bf16_f32 v112, v104, v105
    v_cvt_pk_bf16_f32 v113, v106, v107
    v_cvt_pk_bf16_f32 v114, v108, v109
    v_cvt_pk_bf16_f32 v115, v110, v111
    s_nop 1
    v_permlane16_swap_b32 v112, v114
    v_permlane16_swap_b32 v113, v115
    v_pk_mul_f32 v[120:121], v[120:121], s[80:81] op_sel_hi:[1,0]
    v_pk_mul_f32 v[122:123], v[122:123], s[80:81] op_sel_hi:[1,0]
    v_pk_mul_f32 v[124:125], v[124:125], s[80:81] op_sel_hi:[1,0]
    v_pk_mul_f32 v[126:127], v[126:127], s[80:81] op_sel_hi:[1,0]
    v_exp_f32 v120, v120
    v_exp_f32 v121, v121
    v_exp_f32 v122, v122
    v_exp_f32 v123, v123
    v_exp_f32 v124, v124
    v_exp_f32 v125, v125
    v_exp_f32 v126, v126
    v_exp_f32 v127, v127
    v_pk_add_f32 v[120:121], v[120:121], 1.0 op_sel_hi:[1,0]
    v_pk_add_f32 v[122:123], v[122:123], 1.0 op_sel_hi:[1,0]
    v_pk_add_f32 v[124:125], v[124:125], 1.0 op_sel_hi:[1,0]
    v_pk_add_f32 v[126:127], v[126:127], 1.0 op_sel_hi:[1,0]
    v_rcp_f32 v120, v120
    v_rcp_f32 v121, v121
    v_rcp_f32 v122, v122
    v_rcp_f32 v123, v123
    v_rcp_f32 v124, v124
    v_rcp_f32 v125, v125
    v_rcp_f32 v126, v126
    v_rcp_f32 v127, v127
    v_pk_mul_f32 v[120:121], v[120:121], v[128:129]
    v_pk_mul_f32 v[122:123], v[122:123], v[130:131]
    v_pk_mul_f32 v[124:125], v[124:125], v[132:133]
    v_pk_mul_f32 v[126:127], v[126:127], v[134:135]
    v_cvt_pk_bf16_f32 v128, v120, v121
    v_cvt_pk_bf16_f32 v129, v122, v123
    v_cvt_pk_bf16_f32 v130, v124, v125
    v_cvt_pk_bf16_f32 v131, v126, v127
    s_nop 1
    v_permlane16_swap_b32 v128, v130
    v_permlane16_swap_b32 v129, v131
    s_cmp_eq_u32 s97, 0
    s_cbranch_scc1 L_a_e2
    v_pk_mul_f32 v[136:137], v[136:137], s[80:81] op_sel_hi:[1,0]
    v_pk_mul_f32 v[138:139], v[138:139], s[80:81] op_sel_hi:[1,0]
    v_pk_mul_f32 v[140:141], v[140:141], s[80:81] op_sel_hi:[1,0]
    v_pk_mul_f32 v[142:143], v[142:143], s[80:81] op_sel_hi:[1,0]
    v_exp_f32 v136, v136
    v_exp_f32 v137, v137
    v_exp_f32 v138, v138
    v_exp_f32 v139, v139
    v_exp_f32 v140, v140
    v_exp_f32 v141, v141
    v_exp_f32 v142, v142
    v_exp_f32 v143, v143
    v_pk_add_f32 v[136:137], v[136:137], 1.0 op_sel_hi:[1,0]
    v_pk_add_f32 v[138:139], v[138:139], 1.0 op_sel_hi:[1,0]
    v_pk_add_f32 v[140:141], v[140:141], 1.0 op_sel_hi:[1,0]
    v_pk_add_f32 v[142:143], v[142:143], 1.0 op_sel_hi:[1,0]
    v_rcp_f32 v136, v136
    v_rcp_f32 v137, v137
    v_rcp_f32 v138, v138
    v_rcp_f32 v139, v139
    v_rcp_f32 v140, v140
    v_rcp_f32 v141, v141
    v_rcp_f32 v142, v142
    v_rcp_f32 v143, v143
    v_pk_mul_f32 v[136:137], v[136:137], v[144:145]
    v_pk_mul_f32 v[138:139], v[138:139], v[146:147]
    v_pk_mul_f32 v[140:141], v[140:141], v[148:149]
    v_pk_mul_f32 v[142:143], v[142:143], v[150:151]
    v_cvt_pk_bf16_f32 v144, v136, v137
    v_cvt_pk_bf16_f32 v145, v138, v139
    v_cvt_pk_bf16_f32 v146, v140, v141
    v_cvt_pk_bf16_f32 v147, v142, v143
    s_nop 1
    v_permlane16_swap_b32 v144, v146
    v_permlane16_swap_b32 v145, v147
L_a_e2:
    v_mov_b32 v104, -1
    v_mov_b32 v105, -1
    v_mov_b32 v106, -1
    v_mov_b32 v107, -1
    s_mov_b32 s77, s88
    s_mov_b32 s78, s89
    s_mov_b32 s48, s90
    s_waitcnt vmcnt(0) lgkmcnt(0)
    s_barrier
    ds_read_b128 v[8:11], v153
    ds_read_b128 v[24:27], v154
    s_waitcnt lgkmcnt(1)
    v_mfma_f32_32x32x16_bf16 v[32:47], v[8:11], v[20:23], 0
    s_mov_b32 s76, 0x5f800000
    v_xor_b32 v13, 16, v165
    v_xor_b32 v14, 0x8000, v163
    v_xor_b32 v12, 0x8000, v164
    s_nop 11
    v_exp_f32 v32, v32
    v_exp_f32 v33, v33
    v_smfmac_f32_32x32x32_bf16 v[64:79], v[28:31], v[56:63], v152
    ds_read_b128 v[28:31], v155 offset:0
    v_exp_f32 v34, v34
    v_exp_f32 v35, v35
    v_exp_f32 v36, v36
    v_exp_f32 v37, v37
    v_mfma_f32_32x32x16_bf16 v[48:63], v[8:11], v[16:19], 0
    ds_read_b128 v[8:11], v153 offset:1024
    v_exp_f32 v38, v38
    v_exp_f32 v39, v39
    v_exp_f32 v40, v40
    v_exp_f32 v41, v41
    v_exp_f32 v42, v42
    v_exp_f32 v43, v43
    s_waitcnt lgkmcnt(2)
    v_smfmac_f32_32x32x32_bf16 v[80:95], v[24:27], v[32:39], v152
    v_exp_f32 v44, v44
    v_exp_f32 v45, v45
    v_exp_f32 v46, v46
    v_exp_f32 v47, v47
    v_exp_f32 v48, v48
    v_exp_f32 v49, v49
    s_waitcnt lgkmcnt(0)
    v_smfmac_f32_32x32x32_bf16 v[80:95], v[28:31], v[40:47], v152
    v_exp_f32 v50, v50
    v_exp_f32 v51, v51
    v_exp_f32 v52, v52
    v_exp_f32 v53, v53
    v_mfma_f32_32x32x16_bf16 v[32:47], v[8:11], v[20:23], 0
    v_exp_f32 v54, v54
    v_exp_f32 v55, v55
    v_exp_f32 v56, v56
    v_exp_f32 v57, v57
    v_exp_f32 v58, v58
    v_exp_f32 v59, v59
    v_smfmac_f32_32x32x32_bf16 v[64:79], v[24:27], v[48:55], v152
    ds_read_b128 v[24:27], v154 offset:1040
    v_exp_f32 v60, v60
    v_exp_f32 v61, v61
    v_exp_f32 v62, v62
    v_exp_f32 v63, v63
    v_exp_f32 v32, v32
    v_exp_f32 v33, v33
    v_smfmac_f32_32x32x32_bf16 v[64:79], v[28:31], v[56:63], v152
    ds_read_b128 v[28:31], v155 offset:1040
    v_exp_f32 v34, v34
    v_exp_f32 v35, v35
    v_exp_f32 v36, v36
    v_exp_f32 v37, v37
    v_mfma_f32_32x32x16_bf16 v[48:63], v[8:11], v[16:19], 0
    ds_read_b128 v[8:11], v153 offset:2048
    v_exp_f32 v38, v38
    v_exp_f32 v39, v39
    v_exp_f32 v40, v40
    v_exp_f32 v41, v41
    v_exp_f32 v42, v42
    v_exp_f32 v43, v43
    s_waitcnt lgkmcnt(2)
    v_smfmac_f32_32x32x32_bf16 v[80:95], v[24:27], v[32:39], v152
    v_exp_f32 v44, v44
    v_exp_f32 v45, v45
    v_exp_f32 v46, v46
    v_exp_f32 v47, v47
    v_exp_f32 v48, v48
    v_exp_f32 v49, v49
    s_waitcnt lgkmcnt(0)
    v_smfmac_f32_32x32x32_bf16 v[80:95], v[28:31], v[40:47], v152
    v_exp_f32 v50, v50
    v_exp_f32 v51, v51
    v_exp_f32 v52, v52
    v_exp_f32 v53, v53
    v_mfma_f32_32x32x16_bf16 v[32:47], v[8:11], v[20:23], 0
    v_exp_f32 v54, v54
    v_exp_f32 v55, v55
    v_exp_f32 v56, v56
    v_exp_f32 v57, v57
    v_exp_f32 v58, v58
    v_exp_f32 v59, v59
    v_smfmac_f32_32x32x32_bf16 v[64:79], v[24:27], v[48:55], v152
    ds_read_b128 v[24:27], v154 offset:2080
    v_exp_f32 v60, v60
    v_exp_f32 v61, v61
    v_exp_f32 v62, v62
    v_exp_f32 v63, v63
    v_exp_f32 v32, v32
    v_exp_f32 v33, v33
    v_smfmac_f32_32x32x32_bf16 v[64:79], v[28:31], v[56:63], v152
    ds_read_b128 v[28:31], v155 offset:2080
    v_exp_f32 v34, v34
    v_exp_f32 v35, v35
    v_exp_f32 v36, v36
    v_exp_f32 v37, v37
    v_mfma_f32_32x32x16_bf16 v[48:63], v[8:11], v[16:19], 0
    ds_read_b128 v[8:11], v153 offset:3072
    v_exp_f32 v38, v38
    v_exp_f32 v39, v39
    v_exp_f32 v40, v40
    v_exp_f32 v41, v41
    v_exp_f32 v42, v42
    v_exp_f32 v43, v43
    s_waitcnt lgkmcnt(2)
    v_smfmac_f32_32x32x32_bf16 v[80:95], v[24:27], v[32:39], v152
    v_exp_f32 v44, v44
    v_exp_f32 v45, v45
    v_exp_f32 v46, v46
    v_exp_f32 v47, v47
    v_exp_f32 v48, v48
    v_exp_f32 v49, v49
    s_waitcnt lgkmcnt(0)
    v_smfmac_f32_32x32x32_bf16 v[80:95], v[28:31], v[40:47], v152
    v_exp_f32 v50, v50
    v_exp_f32 v51, v51
    v_exp_f32 v52, v52
    v_exp_f32 v53, v53
    v_mfma_f32_32x32x16_bf16 v[32:47], v[8:11], v[20:23], 0
    v_exp_f32 v54, v54
    v_exp_f32 v55, v55
    v_exp_f32 v56, v56
    v_exp_f32 v57, v57
    v_exp_f32 v58, v58
    v_exp_f32 v59, v59
    v_smfmac_f32_32x32x32_bf16 v[64:79], v[24:27], v[48:55], v152
    ds_read_b128 v[24:27], v154 offset:3120
    v_exp_f32 v60, v60
    v_exp_f32 v61, v61
    v_exp_f32 v62, v62
    v_exp_f32 v63, v63
    v_exp_f32 v32, v32
    v_exp_f32 v33, v33
    v_smfmac_f32_32x32x32_bf16 v[64:79], v[28:31], v[56:63], v152
    ds_read_b128 v[28:31], v155 offset:3120
    v_exp_f32 v34, v34
    v_exp_f32 v35, v35
    v_exp_f32 v36, v36
    v_exp_f32 v37, v37
    v_mfma_f32_32x32x16_bf16 v[48:63], v[8:11], v[16:19], 0
    ds_read_b128 v[8:11], v153 offset:4096
    v_exp_f32 v38, v38
    v_exp_f32 v39, v39
    v_exp_f32 v40, v40
    v_exp_f32 v41, v41
    v_exp_f32 v42, v42
    v_exp_f32 v43, v43
    s_waitcnt lgkmcnt(2)
    v_smfmac_f32_32x32x32_bf16 v[80:95], v[24:27], v[32:39], v152
    v_exp_f32 v44, v44
    v_exp_f32 v45, v45
    v_exp_f32 v46, v46
    v_exp_f32 v47, v47
    v_exp_f32 v48, v48
    v_exp_f32 v49, v49
    s_waitcnt lgkmcnt(0)
    v_smfmac_f32_32x32x32_bf16 v[80:95], v[28:31], v[40:47], v152
    v_exp_f32 v50, v50
    v_exp_f32 v51, v51
    v_exp_f32 v52, v52
    v_exp_f32 v53, v53
    v_mfma_f32_32x32x16_bf16 v[32:47], v[8:11], v[20:23], 0
    v_exp_f32 v54, v54
    v_exp_f32 v55, v55
    v_exp_f32 v56, v56
    v_exp_f32 v57, v57
    v_exp_f32 v58, v58
    v_exp_f32 v59, v59
    v_smfmac_f32_32x32x32_bf16 v[64:79], v[24:27], v[48:55], v152
    ds_read_b128 v[24:27], v154 offset:4160
    v_exp_f32 v60, v60
    v_exp_f32 v61, v61
    v_exp_f32 v62, v62
    v_exp_f32 v63, v63
    v_exp_f32 v32, v32
    v_exp_f32 v33, v33
    v_smfmac_f32_32x32x32_bf16 v[64:79], v[28:31], v[56:63], v152
    ds_read_b128 v[28:31], v155 offset:4160
    v_exp_f32 v34, v34
    v_exp_f32 v35, v35
    v_exp_f32 v36, v36
    v_exp_f32 v37, v37
    v_mfma_f32_32x32x16_bf16 v[48:63], v[8:11], v[16:19], 0
    ds_read_b128 v[8:11], v153 offset:5120
    v_exp_f32 v38, v38
    v_exp_f32 v39, v39
    v_exp_f32 v40, v40
    v_exp_f32 v41, v41
    v_exp_f32 v42, v42
    v_exp_f32 v43, v43
    s_waitcnt lgkmcnt(2)
    v_smfmac_f32_32x32x32_bf16 v[80:95], v[24:27], v[32:39], v152
    v_exp_f32 v44, v44
    v_exp_f32 v45, v45
    v_exp_f32 v46, v46
    v_exp_f32 v47, v47
    v_exp_f32 v48, v48
    v_exp_f32 v49, v49
    s_waitcnt lgkmcnt(0)
    v_smfmac_f32_32x32x32_bf16 v[80:95], v[28:31], v[40:47], v152
    v_exp_f32 v50, v50
    v_exp_f32 v51, v51
    v_exp_f32 v52, v52
    v_exp_f32 v53, v53
    v_mfma_f32_32x32x16_bf16 v[32:47], v[8:11], v[20:23], 0
    v_exp_f32 v54, v54
    v_exp_f32 v55, v55
    v_exp_f32 v56, v56
    v_exp_f32 v57, v57
    v_exp_f32 v58, v58
    v_exp_f32 v59, v59
    v_smfmac_f32_32x32x32_bf16 v[64:79], v[24:27], v[48:55], v152
    ds_read_b128 v[24:27], v154 offset:5200
    v_exp_f32 v60, v60
    v_exp_f32 v61, v61
    v_exp_f32 v62, v62
    v_exp_f32 v63, v63
    buffer_store_dwordx4 v[112:115], v2, s[20:23], s98 offen sc1
    v_exp_f32 v32, v32
    v_exp_f32 v33, v33
    v_smfmac_f32_32x32x32_bf16 v[64:79], v[28:31], v[56:63], v152
    ds_read_b128 v[28:31], v155 offset:5200
    v_exp_f32 v34, v34
    v_exp_f32 v35, v35
    v_exp_f32 v36, v36
    v_exp_f32 v37, v37
    v_mfma_f32_32x32x16_bf16 v[48:63], v[8:11], v[16:19], 0
    ds_read_b128 v[8:11], v153 offset:6144
    v_exp_f32 v38, v38
    v_exp_f32 v39, v39
    v_exp_f32 v40, v40
    v_exp_f32 v41, v41
    v_exp_f32 v42, v42
    v_exp_f32 v43, v43
    s_waitcnt lgkmcnt(2)
    v_smfmac_f32_32x32x32_bf16 v[80:95], v[24:27], v[32:39], v152
    v_exp_f32 v44, v44
    v_exp_f32 v45, v45
    v_exp_f32 v46, v46
    v_exp_f32 v47, v47
    v_exp_f32 v48, v48
    v_exp_f32 v49, v49
    s_waitcnt lgkmcnt(0)
    v_smfmac_f32_32x32x32_bf16 v[80:95], v[28:31], v[40:47], v152
    v_exp_f32 v50, v50
    v_exp_f32 v51, v51
    v_exp_f32 v52, v52
    v_exp_f32 v53, v53
    v_mfma_f32_32x32x16_bf16 v[32:47], v[8:11], v[20:23], 0
    v_exp_f32 v54, v54
    v_exp_f32 v55, v55
    v_exp_f32 v56, v56
    v_exp_f32 v57, v57
    v_exp_f32 v58, v58
    v_exp_f32 v59, v59
    v_smfmac_f32_32x32x32_bf16 v[64:79], v[24:27], v[48:55], v152
    ds_read_b128 v[24:27], v154 offset:6240
    v_exp_f32 v60, v60
    v_exp_f32 v61, v61
    v_exp_f32 v62, v62
    v_exp_f32 v63, v63
    v_exp_f32 v32, v32
    v_exp_f32 v33, v33
    v_smfmac_f32_32x32x32_bf16 v[64:79], v[28:31], v[56:63], v152
    ds_read_b128 v[28:31], v155 offset:6240
    v_exp_f32 v34, v34
    v_exp_f32 v35, v35
    v_exp_f32 v36, v36
    v_exp_f32 v37, v37
    v_mfma_f32_32x32x16_bf16 v[48:63], v[8:11], v[16:19], 0
    ds_read_b128 v[8:11], v153 offset:7168
    v_exp_f32 v38, v38
    v_exp_f32 v39, v39
    v_exp_f32 v40, v40
    v_exp_f32 v41, v41
    v_exp_f32 v42, v42
    v_exp_f32 v43, v43
    s_waitcnt lgkmcnt(2)
    v_smfmac_f32_32x32x32_bf16 v[80:95], v[24:27], v[32:39], v152
    v_exp_f32 v44, v44
    v_exp_f32 v45, v45
    v_exp_f32 v46, v46
    v_exp_f32 v47, v47
    v_exp_f32 v48, v48
    v_exp_f32 v49, v49
    s_waitcnt lgkmcnt(0)
    v_smfmac_f32_32x32x32_bf16 v[80:95], v[28:31], v[40:47], v152
    v_exp_f32 v50, v50
    v_exp_f32 v51, v51
    v_exp_f32 v52, v52
    v_exp_f32 v53, v53
    v_mfma_f32_32x32x16_bf16 v[32:47], v[8:11], v[20:23], 0
    v_exp_f32 v54, v54
    v_exp_f32 v55, v55
    v_exp_f32 v56, v56
    v_exp_f32 v57, v57
    v_exp_f32 v58, v58
    v_exp_f32 v59, v59
    v_smfmac_f32_32x32x32_bf16 v[64:79], v[24:27], v[48:55], v152
    ds_read_b128 v[24:27], v154 offset:7280
    v_exp_f32 v60, v60
    v_exp_f32 v61, v61
    v_exp_f32 v62, v62
    v_exp_f32 v63, v63
L_fw_10:
    ds_read_b32 v6, v162 offset:80
    s_waitcnt lgkmcnt(0)
    v_cmp_eq_u32 vcc, 0, v6
    s_cbranch_vccnz L_rt_12
L_fwd_11:
    s_add_u32 s79, s98, 0x20000
    buffer_store_dwordx4 v[128:131], v2, s[20:23], s79 offen sc1
    v_exp_f32 v32, v32
    v_exp_f32 v33, v33
    v_smfmac_f32_32x32x32_bf16 v[64:79], v[28:31], v[56:63], v152
    ds_read_b128 v[28:31], v155 offset:7280
    v_exp_f32 v34, v34
    v_exp_f32 v35, v35
    v_exp_f32 v36, v36
    v_exp_f32 v37, v37
    v_mfma_f32_32x32x16_bf16 v[48:63], v[8:11], v[16:19], 0
    ds_read_b128 v[8:11], v153 offset:8192
    v_exp_f32 v38, v38
    v_exp_f32 v39, v39
    v_exp_f32 v40, v40
    v_exp_f32 v41, v41
    v_exp_f32 v42, v42
    v_exp_f32 v43, v43
    s_waitcnt lgkmcnt(2)
    v_smfmac_f32_32x32x32_bf16 v[80:95], v[24:27], v[32:39], v152
    v_exp_f32 v44, v44
    v_exp_f32 v45, v45
    v_exp_f32 v46, v46
    v_exp_f32 v47, v47
    v_exp_f32 v48, v48
    v_exp_f32 v49, v49
    s_waitcnt lgkmcnt(0)
    v_smfmac_f32_32x32x32_bf16 v[80:95], v[28:31], v[40:47], v152
    v_exp_f32 v50, v50
    v_exp_f32 v51, v51
    v_exp_f32 v52, v52
    v_exp_f32 v53, v53
    v_mfma_f32_32x32x16_bf16 v[32:47], v[8:11], v[20:23], 0
    v_exp_f32 v54, v54
    v_exp_f32 v55, v55
    v_exp_f32 v56, v56
    v_exp_f32 v57, v57
    v_exp_f32 v58, v58
    v_exp_f32 v59, v59
    v_smfmac_f32_32x32x32_bf16 v[64:79], v[24:27], v[48:55], v152
    ds_read_b128 v[24:27], v154 offset:8320
    v_exp_f32 v60, v60
    v_exp_f32 v61, v61
    v_exp_f32 v62, v62
    v_exp_f32 v63, v63
    v_exp_f32 v32, v32
    v_exp_f32 v33, v33
    v_smfmac_f32_32x32x32_bf16 v[64:79], v[28:31], v[56:63], v152
    ds_read_b128 v[28:31], v155 offset:8320
    v_exp_f32 v34, v34
    v_exp_f32 v35, v35
    v_exp_f32 v36, v36
    v_exp_f32 v37, v37
    v_mfma_f32_32x32x16_bf16 v[48:63], v[8:11], v[16:19], 0
    ds_read_b128 v[8:11], v153 offset:9216
    v_exp_f32 v38, v38
    v_exp_f32 v39, v39
    v_exp_f32 v40, v40
    v_exp_f32 v41, v41
    v_exp_f32 v42, v42
    v_exp_f32 v43, v43
    s_waitcnt lgkmcnt(2)
    v_smfmac_f32_32x32x32_bf16 v[80:95], v[24:27], v[32:39], v152
    v_exp_f32 v44, v44
    v_exp_f32 v45, v45
    v_exp_f32 v46, v46
    v_exp_f32 v47, v47
    v_exp_f32 v48, v48
    v_exp_f32 v49, v49
    s_waitcnt lgkmcnt(0)
    v_smfmac_f32_32x32x32_bf16 v[80:95], v[28:31], v[40:47], v152
    v_exp_f32 v50, v50
    v_exp_f32 v51, v51
    v_exp_f32 v52, v52
    v_exp_f32 v53, v53
    v_mfma_f32_32x32x16_bf16 v[32:47], v[8:11], v[20:23], 0
    v_exp_f32 v54, v54
    v_exp_f32 v55, v55
    v_exp_f32 v56, v56
    v_exp_f32 v57, v57
    v_exp_f32 v58, v58
    v_exp_f32 v59, v59
    v_smfmac_f32_32x32x32_bf16 v[64:79], v[24:27], v[48:55], v152
    ds_read_b128 v[24:27], v154 offset:9360
    v_exp_f32 v60, v60
    v_exp_f32 v61, v61
    v_exp_f32 v62, v62
    v_exp_f32 v63, v63
    s_add_u32 s80, s98, 0x40000
    s_cmp_eq_u32 s97, 0
    s_cmov_b32 s80, 0x40000000
    buffer_store_dwordx4 v[144:147], v2, s[20:23], s80 offen sc1
    v_exp_f32 v32, v32
    v_exp_f32 v33, v33
    v_smfmac_f32_32x32x32_bf16 v[64:79], v[28:31], v[56:63], v152
    ds_read_b128 v[28:31], v155 offset:9360
    v_exp_f32 v34, v34
    v_exp_f32 v35, v35
    v_exp_f32 v36, v36
    v_exp_f32 v37, v37
    v_mfma_f32_32x32x16_bf16 v[48:63], v[8:11], v[16:19], 0
    ds_read_b128 v[8:11], v153 offset:10240
    v_exp_f32 v38, v38
    v_exp_f32 v39, v39
    v_exp_f32 v40, v40
    v_exp_f32 v41, v41
    v_exp_f32 v42, v42
    v_exp_f32 v43, v43
    s_waitcnt lgkmcnt(2)
    v_smfmac_f32_32x32x32_bf16 v[80:95], v[24:27], v[32:39], v152
    v_exp_f32 v44, v44
    v_exp_f32 v45, v45
    v_exp_f32 v46, v46
    v_exp_f32 v47, v47
    v_exp_f32 v48, v48
    v_exp_f32 v49, v49
    s_waitcnt lgkmcnt(0)
    v_smfmac_f32_32x32x32_bf16 v[80:95], v[28:31], v[40:47], v152
    v_exp_f32 v50, v50
    v_exp_f32 v51, v51
    v_exp_f32 v52, v52
    v_exp_f32 v53, v53
    v_mfma_f32_32x32x16_bf16 v[32:47], v[8:11], v[20:23], 0
    v_exp_f32 v54, v54
    v_exp_f32 v55, v55
    v_exp_f32 v56, v56
    v_exp_f32 v57, v57
    v_exp_f32 v58, v58
    v_exp_f32 v59, v59
    v_smfmac_f32_32x32x32_bf16 v[64:79], v[24:27], v[48:55], v152
    ds_read_b128 v[24:27], v154 offset:10400
    v_exp_f32 v60, v60
    v_exp_f32 v61, v61
    v_exp_f32 v62, v62
    v_exp_f32 v63, v63
    v_exp_f32 v32, v32
    v_exp_f32 v33, v33
    v_smfmac_f32_32x32x32_bf16 v[64:79], v[28:31], v[56:63], v152
    ds_read_b128 v[28:31], v155 offset:10400
    v_exp_f32 v34, v34
    v_exp_f32 v35, v35
    v_exp_f32 v36, v36
    v_exp_f32 v37, v37
    v_mfma_f32_32x32x16_bf16 v[48:63], v[8:11], v[16:19], 0
    ds_read_b128 v[8:11], v153 offset:11264
    v_exp_f32 v38, v38
    v_exp_f32 v39, v39
    v_exp_f32 v40, v40
    v_exp_f32 v41, v41
    v_exp_f32 v42, v42
    v_exp_f32 v43, v43
    s_waitcnt lgkmcnt(2)
    v_smfmac_f32_32x32x32_bf16 v[80:95], v[24:27], v[32:39], v152
    v_exp_f32 v44, v44
    v_exp_f32 v45, v45
    v_exp_f32 v46, v46
    v_exp_f32 v47, v47
    v_exp_f32 v48, v48
    v_exp_f32 v49, v49
    s_waitcnt lgkmcnt(0)
    v_smfmac_f32_32x32x32_bf16 v[80:95], v[28:31], v[40:47], v152
    v_exp_f32 v50, v50
    v_exp_f32 v51, v51
    v_exp_f32 v52, v52
    v_exp_f32 v53, v53
    v_mfma_f32_32x32x16_bf16 v[32:47], v[8:11], v[20:23], 0
    v_exp_f32 v54, v54
    v_exp_f32 v55, v55
    v_exp_f32 v56, v56
    v_exp_f32 v57, v57
    v_exp_f32 v58, v58
    v_exp_f32 v59, v59
    v_smfmac_f32_32x32x32_bf16 v[64:79], v[24:27], v[48:55], v152
    ds_read_b128 v[24:27], v154 offset:11440
    v_exp_f32 v60, v60
    v_exp_f32 v61, v61
    v_exp_f32 v62, v62
    v_exp_f32 v63, v63
    s_add_u32 s79, s48, 0x600000
    buffer_store_dwordx4 v[104:107], v2, s[16:19], s79 offen sc1
    v_exp_f32 v32, v32
    v_exp_f32 v33, v33
    v_smfmac_f32_32x32x32_bf16 v[64:79], v[28:31], v[56:63], v152
    ds_read_b128 v[28:31], v155 offset:11440
    v_exp_f32 v34, v34
    v_exp_f32 v35, v35
    v_exp_f32 v36, v36
    v_exp_f32 v37, v37
    v_mfma_f32_32x32x16_bf16 v[48:63], v[8:11], v[16:19], 0
    ds_read_b128 v[8:11], v153 offset:12288
    v_exp_f32 v38, v38
    v_exp_f32 v39, v39
    v_exp_f32 v40, v40
    v_exp_f32 v41, v41
    v_exp_f32 v42, v42
    v_exp_f32 v43, v43
    s_waitcnt lgkmcnt(2)
    v_smfmac_f32_32x32x32_bf16 v[80:95], v[24:27], v[32:39], v152
    v_exp_f32 v44, v44
    v_exp_f32 v45, v45
    v_exp_f32 v46, v46
    v_exp_f32 v47, v47
    v_exp_f32 v48, v48
    v_exp_f32 v49, v49
    s_waitcnt lgkmcnt(0)
    v_smfmac_f32_32x32x32_bf16 v[80:95], v[28:31], v[40:47], v152
    v_exp_f32 v50, v50
    v_exp_f32 v51, v51
    v_exp_f32 v52, v52
    v_exp_f32 v53, v53
    v_mfma_f32_32x32x16_bf16 v[32:47], v[8:11], v[20:23], 0
    v_exp_f32 v54, v54
    v_exp_f32 v55, v55
    v_exp_f32 v56, v56
    v_exp_f32 v57, v57
    v_exp_f32 v58, v58
    v_exp_f32 v59, v59
    v_smfmac_f32_32x32x32_bf16 v[64:79], v[24:27], v[48:55], v152
    ds_read_b128 v[24:27], v154 offset:12480
    v_exp_f32 v60, v60
    v_exp_f32 v61, v61
    v_exp_f32 v62, v62
    v_exp_f32 v63, v63
    s_mov_b64 exec, 1
    ds_add_u32 v156, v5 offset:20
    s_mov_b64 exec, -1
    v_exp_f32 v32, v32
    v_exp_f32 v33, v33
    v_smfmac_f32_32x32x32_bf16 v[64:79], v[28:31], v[56:63], v152
    ds_read_b128 v[28:31], v155 offset:12480
    v_exp_f32 v34, v34
    v_exp_f32 v35, v35
    v_exp_f32 v36, v36
    v_exp_f32 v37, v37
    v_mfma_f32_32x32x16_bf16 v[48:63], v[8:11], v[16:19], 0
    ds_read_b128 v[8:11], v153 offset:13312
    v_exp_f32 v38, v38
    v_exp_f32 v39, v39
    v_exp_f32 v40, v40
    v_exp_f32 v41, v41
    v_exp_f32 v42, v42
    v_exp_f32 v43, v43
    s_waitcnt lgkmcnt(2)
    v_smfmac_f32_32x32x32_bf16 v[80:95], v[24:27], v[32:39], v152
    v_exp_f32 v44, v44
    v_exp_f32 v45, v45
    v_exp_f32 v46, v46
    v_exp_f32 v47, v47
    v_exp_f32 v48, v48
    v_exp_f32 v49, v49
    s_waitcnt lgkmcnt(0)
    v_smfmac_f32_32x32x32_bf16 v[80:95], v[28:31], v[40:47], v152
    v_exp_f32 v50, v50
    v_exp_f32 v51, v51
    v_exp_f32 v52, v52
    v_exp_f32 v53, v53
    v_mfma_f32_32x32x16_bf16 v[32:47], v[8:11], v[20:23], 0
    v_exp_f32 v54, v54
    v_exp_f32 v55, v55
    v_exp_f32 v56, v56
    v_exp_f32 v57, v57
    v_exp_f32 v58, v58
    v_exp_f32 v59, v59
    v_smfmac_f32_32x32x32_bf16 v[64:79], v[24:27], v[48:55], v152
    ds_read_b128 v[24:27], v154 offset:13520
    v_exp_f32 v60, v60
    v_exp_f32 v61, v61
    v_exp_f32 v62, v62
    v_exp_f32 v63, v63
    v_exp_f32 v32, v32
    v_exp_f32 v33, v33
    v_smfmac_f32_32x32x32_bf16 v[64:79], v[28:31], v[56:63], v152
    ds_read_b128 v[28:31], v155 offset:13520
    v_exp_f32 v34, v34
    v_exp_f32 v35, v35
    v_exp_f32 v36, v36
    v_exp_f32 v37, v37
    v_mfma_f32_32x32x16_bf16 v[48:63], v[8:11], v[16:19], 0
    ds_read_b128 v[8:11], v153 offset:14336
    v_exp_f32 v38, v38
    v_exp_f32 v39, v39
    v_exp_f32 v40, v40
    v_exp_f32 v41, v41
    v_exp_f32 v42, v42
    v_exp_f32 v43, v43
    s_waitcnt lgkmcnt(2)
    v_smfmac_f32_32x32x32_bf16 v[80:95], v[24:27], v[32:39], v152
    v_exp_f32 v44, v44
    v_exp_f32 v45, v45
    v_exp_f32 v46, v46
    v_exp_f32 v47, v47
    v_exp_f32 v48, v48
    v_exp_f32 v49, v49
    s_waitcnt lgkmcnt(0)
    v_smfmac_f32_32x32x32_bf16 v[80:95], v[28:31], v[40:47], v152
    v_exp_f32 v50, v50
    v_exp_f32 v51, v51
    v_exp_f32 v52, v52
    v_exp_f32 v53, v53
    v_mfma_f32_32x32x16_bf16 v[32:47], v[8:11], v[20:23], 0
    v_exp_f32 v54, v54
    v_exp_f32 v55, v55
    v_exp_f32 v56, v56
    v_exp_f32 v57, v57
    v_exp_f32 v58, v58
    v_exp_f32 v59, v59
    v_smfmac_f32_32x32x32_bf16 v[64:79], v[24:27], v[48:55], v152
    ds_read_b128 v[24:27], v154 offset:14560
    v_exp_f32 v60, v60
    v_exp_f32 v61, v61
    v_exp_f32 v62, v62
    v_exp_f32 v63, v63
    s_waitcnt vmcnt(0)
    v_mov_b32 v3, s70
    s_mov_b64 exec, 1
    buffer_store_dword v3, off, s[16:19], s99 sc1
    s_mov_b64 exec, -1
    v_exp_f32 v32, v32
    v_exp_f32 v33, v33
    v_smfmac_f32_32x32x32_bf16 v[64:79], v[28:31], v[56:63], v152
    ds_read_b128 v[28:31], v155 offset:14560
    v_exp_f32 v34, v34
    v_exp_f32 v35, v35
    v_exp_f32 v36, v36
    v_exp_f32 v37, v37
    v_mfma_f32_32x32x16_bf16 v[48:63], v[8:11], v[16:19], 0
    ds_read_b128 v[8:11], v153 offset:15360
    v_exp_f32 v38, v38
    v_exp_f32 v39, v39
    v_exp_f32 v40, v40
    v_exp_f32 v41, v41
    v_exp_f32 v42, v42
    v_exp_f32 v43, v43
    s_waitcnt lgkmcnt(2)
    v_smfmac_f32_32x32x32_bf16 v[80:95], v[24:27], v[32:39], v152
    v_exp_f32 v44, v44
    v_exp_f32 v45, v45
    v_exp_f32 v46, v46
    v_exp_f32 v47, v47
    v_exp_f32 v48, v48
    v_exp_f32 v49, v49
    s_waitcnt lgkmcnt(0)
    v_smfmac_f32_32x32x32_bf16 v[80:95], v[28:31], v[40:47], v152
    v_exp_f32 v50, v50
    v_exp_f32 v51, v51
    v_exp_f32 v52, v52
    v_exp_f32 v53, v53
    v_mfma_f32_32x32x16_bf16 v[32:47], v[8:11], v[20:23], 0
    v_exp_f32 v54, v54
    v_exp_f32 v55, v55
    v_exp_f32 v56, v56
    v_exp_f32 v57, v57
    v_exp_f32 v58, v58
    v_exp_f32 v59, v59
    v_smfmac_f32_32x32x32_bf16 v[64:79], v[24:27], v[48:55], v152
    ds_read_b128 v[24:27], v154 offset:15600
    v_exp_f32 v60, v60
    v_exp_f32 v61, v61
    v_exp_f32 v62, v62
    v_exp_f32 v63, v63
    s_cmp_eq_u32 s75, 0
    s_cbranch_scc1 L_pr_13
L_pr_13_r:
    v_exp_f32 v32, v32
    v_exp_f32 v33, v33
    v_smfmac_f32_32x32x32_bf16 v[64:79], v[28:31], v[56:63], v152
    ds_read_b128 v[28:31], v155 offset:15600
    v_exp_f32 v34, v34
    v_exp_f32 v35, v35
    v_exp_f32 v36, v36
    v_exp_f32 v37, v37
    v_mfma_f32_32x32x16_bf16 v[48:63], v[8:11], v[16:19], 0
    ds_read_b128 v[8:11], v153 offset:16384
    v_exp_f32 v38, v38
    v_exp_f32 v39, v39
    v_exp_f32 v40, v40
    v_exp_f32 v41, v41
    v_exp_f32 v42, v42
    v_exp_f32 v43, v43
    s_waitcnt lgkmcnt(2)
    v_smfmac_f32_32x32x32_bf16 v[80:95], v[24:27], v[32:39], v152
    v_exp_f32 v44, v44
    v_exp_f32 v45, v45
    v_exp_f32 v46, v46
    v_exp_f32 v47, v47
    v_exp_f32 v48, v48
    v_exp_f32 v49, v49
    s_waitcnt lgkmcnt(0)
    v_smfmac_f32_32x32x32_bf16 v[80:95], v[28:31], v[40:47], v152
    v_exp_f32 v50, v50
    v_exp_f32 v51, v51
    v_exp_f32 v52, v52
    v_exp_f32 v53, v53
    v_mfma_f32_32x32x16_bf16 v[32:47], v[8:11], v[20:23], 0
    v_exp_f32 v54, v54
    v_exp_f32 v55, v55
    v_exp_f32 v56, v56
    v_exp_f32 v57, v57
    v_exp_f32 v58, v58
    v_exp_f32 v59, v59
    v_smfmac_f32_32x32x32_bf16 v[64:79], v[24:27], v[48:55], v152
    ds_read_b128 v[24:27], v154 offset:16640
    v_exp_f32 v60, v60
    v_exp_f32 v61, v61
    v_exp_f32 v62, v62
    v_exp_f32 v63, v63
    v_exp_f32 v32, v32
    v_exp_f32 v33, v33
    v_smfmac_f32_32x32x32_bf16 v[64:79], v[28:31], v[56:63], v152
    ds_read_b128 v[28:31], v155 offset:16640
    v_exp_f32 v34, v34
    v_exp_f32 v35, v35
    v_exp_f32 v36, v36
    v_exp_f32 v37, v37
    v_mfma_f32_32x32x16_bf16 v[48:63], v[8:11], v[16:19], 0
    ds_read_b128 v[8:11], v153 offset:17408
    v_exp_f32 v38, v38
    v_exp_f32 v39, v39
    v_exp_f32 v40, v40
    v_exp_f32 v41, v41
    v_exp_f32 v42, v42
    v_exp_f32 v43, v43
    s_waitcnt lgkmcnt(2)
    v_smfmac_f32_32x32x32_bf16 v[80:95], v[24:27], v[32:39], v152
    v_exp_f32 v44, v44
    v_exp_f32 v45, v45
    v_exp_f32 v46, v46
    v_exp_f32 v47, v47
    v_exp_f32 v48, v48
    v_exp_f32 v49, v49
    s_waitcnt lgkmcnt(0)
    v_smfmac_f32_32x32x32_bf16 v[80:95], v[28:31], v[40:47], v152
    v_exp_f32 v50, v50
    v_exp_f32 v51, v51
    v_exp_f32 v52, v52
    v_exp_f32 v53, v53
    v_mfma_f32_32x32x16_bf16 v[32:47], v[8:11], v[20:23], 0
    v_exp_f32 v54, v54
    v_exp_f32 v55, v55
    v_exp_f32 v56, v56
    v_exp_f32 v57, v57
    v_exp_f32 v58, v58
    v_exp_f32 v59, v59
    v_smfmac_f32_32x32x32_bf16 v[64:79], v[24:27], v[48:55], v152
    ds_read_b128 v[24:27], v154 offset:17680
    v_exp_f32 v60, v60
    v_exp_f32 v61, v61
    v_exp_f32 v62, v62
    v_exp_f32 v63, v63
    v_exp_f32 v32, v32
    v_exp_f32 v33, v33
    v_smfmac_f32_32x32x32_bf16 v[64:79], v[28:31], v[56:63], v152
    ds_read_b128 v[28:31], v155 offset:17680
    v_exp_f32 v34, v34
    v_exp_f32 v35, v35
    v_exp_f32 v36, v36
    v_exp_f32 v37, v37
    v_mfma_f32_32x32x16_bf16 v[48:63], v[8:11], v[16:19], 0
    ds_read_b128 v[8:11], v153 offset:18432
    v_exp_f32 v38, v38
    v_exp_f32 v39, v39
    v_exp_f32 v40, v40
    v_exp_f32 v41, v41
    v_exp_f32 v42, v42
    v_exp_f32 v43, v43
    s_waitcnt lgkmcnt(2)
    v_smfmac_f32_32x32x32_bf16 v[80:95], v[24:27], v[32:39], v152
    v_exp_f32 v44, v44
    v_exp_f32 v45, v45
    v_exp_f32 v46, v46
    v_exp_f32 v47, v47
    v_exp_f32 v48, v48
    v_exp_f32 v49, v49
    s_waitcnt lgkmcnt(0)
    v_smfmac_f32_32x32x32_bf16 v[80:95], v[28:31], v[40:47], v152
    v_exp_f32 v50, v50
    v_exp_f32 v51, v51
    v_exp_f32 v52, v52
    v_exp_f32 v53, v53
    v_mfma_f32_32x32x16_bf16 v[32:47], v[8:11], v[20:23], 0
    v_exp_f32 v54, v54
    v_exp_f32 v55, v55
    v_exp_f32 v56, v56
    v_exp_f32 v57, v57
    v_exp_f32 v58, v58
    v_exp_f32 v59, v59
    v_smfmac_f32_32x32x32_bf16 v[64:79], v[24:27], v[48:55], v152
    ds_read_b128 v[24:27], v154 offset:18720
    v_exp_f32 v60, v60
    v_exp_f32 v61, v61
    v_exp_f32 v62, v62
    v_exp_f32 v63, v63
    v_exp_f32 v32, v32
    v_exp_f32 v33, v33
    v_smfmac_f32_32x32x32_bf16 v[64:79], v[28:31], v[56:63], v152
    ds_read_b128 v[28:31], v155 offset:18720
    v_exp_f32 v34, v34
    v_exp_f32 v35, v35
    v_exp_f32 v36, v36
    v_exp_f32 v37, v37
    v_mfma_f32_32x32x16_bf16 v[48:63], v[8:11], v[16:19], 0
    ds_read_b128 v[8:11], v153 offset:19456
    v_exp_f32 v38, v38
    v_exp_f32 v39, v39
    v_exp_f32 v40, v40
    v_exp_f32 v41, v41
    v_exp_f32 v42, v42
    v_exp_f32 v43, v43
    s_waitcnt lgkmcnt(2)
    v_smfmac_f32_32x32x32_bf16 v[80:95], v[24:27], v[32:39], v152
    v_exp_f32 v44, v44
    v_exp_f32 v45, v45
    v_exp_f32 v46, v46
    v_exp_f32 v47, v47
    v_exp_f32 v48, v48
    v_exp_f32 v49, v49
    s_waitcnt lgkmcnt(0)
    v_smfmac_f32_32x32x32_bf16 v[80:95], v[28:31], v[40:47], v152
    v_exp_f32 v50, v50
    v_exp_f32 v51, v51
    v_exp_f32 v52, v52
    v_exp_f32 v53, v53
    v_mfma_f32_32x32x16_bf16 v[32:47], v[8:11], v[20:23], 0
    v_exp_f32 v54, v54
    v_exp_f32 v55, v55
    v_exp_f32 v56, v56
    v_exp_f32 v57, v57
    v_exp_f32 v58, v58
    v_exp_f32 v59, v59
    v_smfmac_f32_32x32x32_bf16 v[64:79], v[24:27], v[48:55], v152
    ds_read_b128 v[24:27], v154 offset:19760
    v_exp_f32 v60, v60
    v_exp_f32 v61, v61
    v_exp_f32 v62, v62
    v_exp_f32 v63, v63
    v_exp_f32 v32, v32
    v_exp_f32 v33, v33
    v_smfmac_f32_32x32x32_bf16 v[64:79], v[28:31], v[56:63], v152
    ds_read_b128 v[28:31], v155 offset:19760
    v_exp_f32 v34, v34
    v_exp_f32 v35, v35
    v_exp_f32 v36, v36
    v_exp_f32 v37, v37
    v_mfma_f32_32x32x16_bf16 v[48:63], v[8:11], v[16:19], 0
    ds_read_b128 v[8:11], v153 offset:20480
    v_exp_f32 v38, v38
    v_exp_f32 v39, v39
    v_exp_f32 v40, v40
    v_exp_f32 v41, v41
    v_exp_f32 v42, v42
    v_exp_f32 v43, v43
    s_waitcnt lgkmcnt(2)
    v_smfmac_f32_32x32x32_bf16 v[80:95], v[24:27], v[32:39], v152
    v_exp_f32 v44, v44
    v_exp_f32 v45, v45
    v_exp_f32 v46, v46
    v_exp_f32 v47, v47
    v_exp_f32 v48, v48
    v_exp_f32 v49, v49
    s_waitcnt lgkmcnt(0)
    v_smfmac_f32_32x32x32_bf16 v[80:95], v[28:31], v[40:47], v152
    v_exp_f32 v50, v50
    v_exp_f32 v51, v51
    v_exp_f32 v52, v52
    v_exp_f32 v53, v53
    v_mfma_f32_32x32x16_bf16 v[32:47], v[8:11], v[20:23], 0
    v_exp_f32 v54, v54
    v_exp_f32 v55, v55
    v_exp_f32 v56, v56
    v_exp_f32 v57, v57
    v_exp_f32 v58, v58
    v_exp_f32 v59, v59
    v_smfmac_f32_32x32x32_bf16 v[64:79], v[24:27], v[48:55], v152
    ds_read_b128 v[24:27], v154 offset:20800
    v_exp_f32 v60, v60
    v_exp_f32 v61, v61
    v_exp_f32 v62, v62
    v_exp_f32 v63, v63
    v_exp_f32 v32, v32
    v_exp_f32 v33, v33
    v_smfmac_f32_32x32x32_bf16 v[64:79], v[28:31], v[56:63], v152
    ds_read_b128 v[28:31], v155 offset:20800
    v_exp_f32 v34, v34
    v_exp_f32 v35, v35
    v_exp_f32 v36, v36
    v_exp_f32 v37, v37
    v_mfma_f32_32x32x16_bf16 v[48:63], v[8:11], v[16:19], 0
    ds_read_b128 v[8:11], v153 offset:21504
    v_exp_f32 v38, v38
    v_exp_f32 v39, v39
    v_exp_f32 v40, v40
    v_exp_f32 v41, v41
    v_exp_f32 v42, v42
    v_exp_f32 v43, v43
    s_waitcnt lgkmcnt(2)
    v_smfmac_f32_32x32x32_bf16 v[80:95], v[24:27], v[32:39], v152
    v_exp_f32 v44, v44
    v_exp_f32 v45, v45
    v_exp_f32 v46, v46
    v_exp_f32 v47, v47
    v_exp_f32 v48, v48
    v_exp_f32 v49, v49
    s_waitcnt lgkmcnt(0)
    v_smfmac_f32_32x32x32_bf16 v[80:95], v[28:31], v[40:47], v152
    v_exp_f32 v50, v50
    v_exp_f32 v51, v51
    v_exp_f32 v52, v52
    v_exp_f32 v53, v53
    v_mfma_f32_32x32x16_bf16 v[32:47], v[8:11], v[20:23], 0
    v_exp_f32 v54, v54
    v_exp_f32 v55, v55
    v_exp_f32 v56, v56
    v_exp_f32 v57, v57
    v_exp_f32 v58, v58
    v_exp_f32 v59, v59
    v_smfmac_f32_32x32x32_bf16 v[64:79], v[24:27], v[48:55], v152
    ds_read_b128 v[24:27], v154 offset:21840
    v_exp_f32 v60, v60
    v_exp_f32 v61, v61
    v_exp_f32 v62, v62
    v_exp_f32 v63, v63
    s_cmp_eq_u32 s75, 1
    s_cbranch_scc1 L_pr_14
L_pr_14_r:
    s_lshr_b32 s79, s77, 1
    s_lshl_b32 s79, s79, 5
    s_and_b32 s80, s77, 1
    s_add_u32 s79, s79, s80
    s_lshl_b32 s79, s79, 7
    s_add_u32 s79, s79, 0xd28f00
    buffer_load_dword v3, off, s[16:19], s79 sc1
    v_exp_f32 v32, v32
    v_exp_f32 v33, v33
    v_smfmac_f32_32x32x32_bf16 v[64:79], v[28:31], v[56:63], v152
    ds_read_b128 v[28:31], v155 offset:21840
    v_exp_f32 v34, v34
    v_exp_f32 v35, v35
    v_exp_f32 v36, v36
    v_exp_f32 v37, v37
    v_mfma_f32_32x32x16_bf16 v[48:63], v[8:11], v[16:19], 0
    ds_read_b128 v[8:11], v153 offset:22528
    v_exp_f32 v38, v38
    v_exp_f32 v39, v39
    v_exp_f32 v40, v40
    v_exp_f32 v41, v41
    v_exp_f32 v42, v42
    v_exp_f32 v43, v43
    s_waitcnt lgkmcnt(2)
    v_smfmac_f32_32x32x32_bf16 v[80:95], v[24:27], v[32:39], v152
    v_exp_f32 v44, v44
    v_exp_f32 v45, v45
    v_exp_f32 v46, v46
    v_exp_f32 v47, v47
    v_exp_f32 v48, v48
    v_exp_f32 v49, v49
    s_waitcnt lgkmcnt(0)
    v_smfmac_f32_32x32x32_bf16 v[80:95], v[28:31], v[40:47], v152
    v_exp_f32 v50, v50
    v_exp_f32 v51, v51
    v_exp_f32 v52, v52
    v_exp_f32 v53, v53
    v_mfma_f32_32x32x16_bf16 v[32:47], v[8:11], v[20:23], 0
    v_exp_f32 v54, v54
    v_exp_f32 v55, v55
    v_exp_f32 v56, v56
    v_exp_f32 v57, v57
    v_exp_f32 v58, v58
    v_exp_f32 v59, v59
    v_smfmac_f32_32x32x32_bf16 v[64:79], v[24:27], v[48:55], v152
    ds_read_b128 v[24:27], v154 offset:22880
    v_exp_f32 v60, v60
    v_exp_f32 v61, v61
    v_exp_f32 v62, v62
    v_exp_f32 v63, v63
    v_exp_f32 v32, v32
    v_exp_f32 v33, v33
    v_smfmac_f32_32x32x32_bf16 v[64:79], v[28:31], v[56:63], v152
    ds_read_b128 v[28:31], v155 offset:22880
    v_exp_f32 v34, v34
    v_exp_f32 v35, v35
    v_exp_f32 v36, v36
    v_exp_f32 v37, v37
    v_mfma_f32_32x32x16_bf16 v[48:63], v[8:11], v[16:19], 0
    ds_read_b128 v[8:11], v153 offset:23552
    v_exp_f32 v38, v38
    v_exp_f32 v39, v39
    v_exp_f32 v40, v40
    v_exp_f32 v41, v41
    v_exp_f32 v42, v42
    v_exp_f32 v43, v43
    s_waitcnt lgkmcnt(2)
    v_smfmac_f32_32x32x32_bf16 v[80:95], v[24:27], v[32:39], v152
    v_exp_f32 v44, v44
    v_exp_f32 v45, v45
    v_exp_f32 v46, v46
    v_exp_f32 v47, v47
    v_exp_f32 v48, v48
    v_exp_f32 v49, v49
    s_waitcnt lgkmcnt(0)
    v_smfmac_f32_32x32x32_bf16 v[80:95], v[28:31], v[40:47], v152
    v_exp_f32 v50, v50
    v_exp_f32 v51, v51
    v_exp_f32 v52, v52
    v_exp_f32 v53, v53
    v_mfma_f32_32x32x16_bf16 v[32:47], v[8:11], v[20:23], 0
    v_exp_f32 v54, v54
    v_exp_f32 v55, v55
    v_exp_f32 v56, v56
    v_exp_f32 v57, v57
    v_exp_f32 v58, v58
    v_exp_f32 v59, v59
    v_smfmac_f32_32x32x32_bf16 v[64:79], v[24:27], v[48:55], v152
    ds_read_b128 v[24:27], v154 offset:23920
    v_exp_f32 v60, v60
    v_exp_f32 v61, v61
    v_exp_f32 v62, v62
    v_exp_f32 v63, v63
    v_exp_f32 v32, v32
    v_exp_f32 v33, v33
    v_smfmac_f32_32x32x32_bf16 v[64:79], v[28:31], v[56:63], v152
    ds_read_b128 v[28:31], v155 offset:23920
    v_exp_f32 v34, v34
    v_exp_f32 v35, v35
    v_exp_f32 v36, v36
    v_exp_f32 v37, v37
    v_mfma_f32_32x32x16_bf16 v[48:63], v[8:11], v[16:19], 0
    ds_read_b128 v[8:11], v153 offset:24576
    v_exp_f32 v38, v38
    v_exp_f32 v39, v39
    v_exp_f32 v40, v40
    v_exp_f32 v41, v41
    v_exp_f32 v42, v42
    v_exp_f32 v43, v43
    s_waitcnt lgkmcnt(2)
    v_smfmac_f32_32x32x32_bf16 v[80:95], v[24:27], v[32:39], v152
    v_exp_f32 v44, v44
    v_exp_f32 v45, v45
    v_exp_f32 v46, v46
    v_exp_f32 v47, v47
    v_exp_f32 v48, v48
    v_exp_f32 v49, v49
    s_waitcnt lgkmcnt(0)
    v_smfmac_f32_32x32x32_bf16 v[80:95], v[28:31], v[40:47], v152
    v_exp_f32 v50, v50
    v_exp_f32 v51, v51
    v_exp_f32 v52, v52
    v_exp_f32 v53, v53
    v_mfma_f32_32x32x16_bf16 v[32:47], v[8:11], v[20:23], 0
    v_exp_f32 v54, v54
    v_exp_f32 v55, v55
    v_exp_f32 v56, v56
    v_exp_f32 v57, v57
    v_exp_f32 v58, v58
    v_exp_f32 v59, v59
    v_smfmac_f32_32x32x32_bf16 v[64:79], v[24:27], v[48:55], v152
    ds_read_b128 v[24:27], v154 offset:24960
    v_exp_f32 v60, v60
    v_exp_f32 v61, v61
    v_exp_f32 v62, v62
    v_exp_f32 v63, v63
    v_exp_f32 v32, v32
    v_exp_f32 v33, v33
    v_smfmac_f32_32x32x32_bf16 v[64:79], v[28:31], v[56:63], v152
    ds_read_b128 v[28:31], v155 offset:24960
    v_exp_f32 v34, v34
    v_exp_f32 v35, v35
    v_exp_f32 v36, v36
    v_exp_f32 v37, v37
    v_mfma_f32_32x32x16_bf16 v[48:63], v[8:11], v[16:19], 0
    ds_read_b128 v[8:11], v153 offset:25600
    v_exp_f32 v38, v38
    v_exp_f32 v39, v39
    v_exp_f32 v40, v40
    v_exp_f32 v41, v41
    v_exp_f32 v42, v42
    v_exp_f32 v43, v43
    s_waitcnt lgkmcnt(2)
    v_smfmac_f32_32x32x32_bf16 v[80:95], v[24:27], v[32:39], v152
    v_exp_f32 v44, v44
    v_exp_f32 v45, v45
    v_exp_f32 v46, v46
    v_exp_f32 v47, v47
    v_exp_f32 v48, v48
    v_exp_f32 v49, v49
    s_waitcnt lgkmcnt(0)
    v_smfmac_f32_32x32x32_bf16 v[80:95], v[28:31], v[40:47], v152
    v_exp_f32 v50, v50
    v_exp_f32 v51, v51
    v_exp_f32 v52, v52
    v_exp_f32 v53, v53
    v_mfma_f32_32x32x16_bf16 v[32:47], v[8:11], v[20:23], 0
    v_exp_f32 v54, v54
    v_exp_f32 v55, v55
    v_exp_f32 v56, v56
    v_exp_f32 v57, v57
    v_exp_f32 v58, v58
    v_exp_f32 v59, v59
    v_smfmac_f32_32x32x32_bf16 v[64:79], v[24:27], v[48:55], v152
    ds_read_b128 v[24:27], v154 offset:26000
    v_exp_f32 v60, v60
    v_exp_f32 v61, v61
    v_exp_f32 v62, v62
    v_exp_f32 v63, v63
    s_waitcnt vmcnt(0)
    v_cmp_ne_u32 vcc, s70, v3
    s_lshl_b32 s80, s77, 7
    s_add_u32 s80, s80, 0xc00000
    s_cbranch_vccnz L_a_gr
L_a_gk:
    buffer_load_dword v157, v159, s[16:19], s80 offen sc1
    v_exp_f32 v32, v32
    v_exp_f32 v33, v33
    v_smfmac_f32_32x32x32_bf16 v[64:79], v[28:31], v[56:63], v152
    ds_read_b128 v[28:31], v155 offset:26000
    v_exp_f32 v34, v34
    v_exp_f32 v35, v35
    v_exp_f32 v36, v36
    v_exp_f32 v37, v37
    v_mfma_f32_32x32x16_bf16 v[48:63], v[8:11], v[16:19], 0
    ds_read_b128 v[8:11], v153 offset:26624
    v_exp_f32 v38, v38
    v_exp_f32 v39, v39
    v_exp_f32 v40, v40
    v_exp_f32 v41, v41
    v_exp_f32 v42, v42
    v_exp_f32 v43, v43
    s_waitcnt lgkmcnt(2)
    v_smfmac_f32_32x32x32_bf16 v[80:95], v[24:27], v[32:39], v152
    v_exp_f32 v44, v44
    v_exp_f32 v45, v45
    v_exp_f32 v46, v46
    v_exp_f32 v47, v47
    v_exp_f32 v48, v48
    v_exp_f32 v49, v49
    s_waitcnt lgkmcnt(0)
    v_smfmac_f32_32x32x32_bf16 v[80:95], v[28:31], v[40:47], v152
    v_exp_f32 v50, v50
    v_exp_f32 v51, v51
    v_exp_f32 v52, v52
    v_exp_f32 v53, v53
    v_mfma_f32_32x32x16_bf16 v[32:47], v[8:11], v[20:23], 0
    v_exp_f32 v54, v54
    v_exp_f32 v55, v55
    v_exp_f32 v56, v56
    v_exp_f32 v57, v57
    v_exp_f32 v58, v58
    v_exp_f32 v59, v59
    v_smfmac_f32_32x32x32_bf16 v[64:79], v[24:27], v[48:55], v152
    ds_read_b128 v[24:27], v154 offset:27040
    v_exp_f32 v60, v60
    v_exp_f32 v61, v61
    v_exp_f32 v62, v62
    v_exp_f32 v63, v63
    v_exp_f32 v32, v32
    v_exp_f32 v33, v33
    v_smfmac_f32_32x32x32_bf16 v[64:79], v[28:31], v[56:63], v152
    ds_read_b128 v[28:31], v155 offset:27040
    v_exp_f32 v34, v34
    v_exp_f32 v35, v35
    v_exp_f32 v36, v36
    v_exp_f32 v37, v37
    v_mfma_f32_32x32x16_bf16 v[48:63], v[8:11], v[16:19], 0
    ds_read_b128 v[8:11], v153 offset:27648
    v_exp_f32 v38, v38
    v_exp_f32 v39, v39
    v_exp_f32 v40, v40
    v_exp_f32 v41, v41
    v_exp_f32 v42, v42
    v_exp_f32 v43, v43
    s_waitcnt lgkmcnt(2)
    v_smfmac_f32_32x32x32_bf16 v[80:95], v[24:27], v[32:39], v152
    v_exp_f32 v44, v44
    v_exp_f32 v45, v45
    v_exp_f32 v46, v46
    v_exp_f32 v47, v47
    v_exp_f32 v48, v48
    v_exp_f32 v49, v49
    s_waitcnt lgkmcnt(0)
    v_smfmac_f32_32x32x32_bf16 v[80:95], v[28:31], v[40:47], v152
    v_exp_f32 v50, v50
    v_exp_f32 v51, v51
    v_exp_f32 v52, v52
    v_exp_f32 v53, v53
    v_mfma_f32_32x32x16_bf16 v[32:47], v[8:11], v[20:23], 0
    v_exp_f32 v54, v54
    v_exp_f32 v55, v55
    v_exp_f32 v56, v56
    v_exp_f32 v57, v57
    v_exp_f32 v58, v58
    v_exp_f32 v59, v59
    v_smfmac_f32_32x32x32_bf16 v[64:79], v[24:27], v[48:55], v152
    ds_read_b128 v[24:27], v154 offset:28080
    v_exp_f32 v60, v60
    v_exp_f32 v61, v61
    v_exp_f32 v62, v62
    v_exp_f32 v63, v63
L_lw_18:
    ds_read_b32 v6, v156 offset:20
    s_waitcnt lgkmcnt(0)
    v_readfirstlane_b32 s82, v6
    s_cmp_ge_u32 s82, 4
    s_cbranch_scc0 L_rt_20
L_lwd_19:
    v_exp_f32 v32, v32
    v_exp_f32 v33, v33
    v_smfmac_f32_32x32x32_bf16 v[64:79], v[28:31], v[56:63], v152
    ds_read_b128 v[28:31], v155 offset:28080
    v_exp_f32 v34, v34
    v_exp_f32 v35, v35
    v_exp_f32 v36, v36
    v_exp_f32 v37, v37
    v_mfma_f32_32x32x16_bf16 v[48:63], v[8:11], v[16:19], 0
    ds_read_b128 v[8:11], v153 offset:28672
    v_exp_f32 v38, v38
    v_exp_f32 v39, v39
    v_exp_f32 v40, v40
    v_exp_f32 v41, v41
    v_exp_f32 v42, v42
    v_exp_f32 v43, v43
    s_waitcnt lgkmcnt(2)
    v_smfmac_f32_32x32x32_bf16 v[80:95], v[24:27], v[32:39], v152
    v_exp_f32 v44, v44
    v_exp_f32 v45, v45
    v_exp_f32 v46, v46
    v_exp_f32 v47, v47
    v_exp_f32 v48, v48
    v_exp_f32 v49, v49
    s_waitcnt lgkmcnt(0)
    v_smfmac_f32_32x32x32_bf16 v[80:95], v[28:31], v[40:47], v152
    v_exp_f32 v50, v50
    v_exp_f32 v51, v51
    v_exp_f32 v52, v52
    v_exp_f32 v53, v53
    v_mfma_f32_32x32x16_bf16 v[32:47], v[8:11], v[20:23], 0
    v_exp_f32 v54, v54
    v_exp_f32 v55, v55
    v_exp_f32 v56, v56
    v_exp_f32 v57, v57
    v_exp_f32 v58, v58
    v_exp_f32 v59, v59
    v_smfmac_f32_32x32x32_bf16 v[64:79], v[24:27], v[48:55], v152
    ds_read_b128 v[24:27], v154 offset:29120
    v_exp_f32 v60, v60
    v_exp_f32 v61, v61
    v_exp_f32 v62, v62
    v_exp_f32 v63, v63
    s_cmp_eq_u32 s75, 0
    s_cbranch_scc1 L_pr_21
L_pr_21_r:
    v_exp_f32 v32, v32
    v_exp_f32 v33, v33
    v_smfmac_f32_32x32x32_bf16 v[64:79], v[28:31], v[56:63], v152
    ds_read_b128 v[28:31], v155 offset:29120
    v_exp_f32 v34, v34
    v_exp_f32 v35, v35
    v_exp_f32 v36, v36
    v_exp_f32 v37, v37
    v_mfma_f32_32x32x16_bf16 v[48:63], v[8:11], v[16:19], 0
    ds_read_b128 v[8:11], v153 offset:29696
    v_exp_f32 v38, v38
    v_exp_f32 v39, v39
    v_exp_f32 v40, v40
    v_exp_f32 v41, v41
    v_exp_f32 v42, v42
    v_exp_f32 v43, v43
    s_waitcnt lgkmcnt(2)
    v_smfmac_f32_32x32x32_bf16 v[80:95], v[24:27], v[32:39], v152
    v_exp_f32 v44, v44
    v_exp_f32 v45, v45
    v_exp_f32 v46, v46
    v_exp_f32 v47, v47
    v_exp_f32 v48, v48
    v_exp_f32 v49, v49
    s_waitcnt lgkmcnt(0)
    v_smfmac_f32_32x32x32_bf16 v[80:95], v[28:31], v[40:47], v152
    v_exp_f32 v50, v50
    v_exp_f32 v51, v51
    v_exp_f32 v52, v52
    v_exp_f32 v53, v53
    v_mfma_f32_32x32x16_bf16 v[32:47], v[8:11], v[20:23], 0
    v_exp_f32 v54, v54
    v_exp_f32 v55, v55
    v_exp_f32 v56, v56
    v_exp_f32 v57, v57
    v_exp_f32 v58, v58
    v_exp_f32 v59, v59
    v_smfmac_f32_32x32x32_bf16 v[64:79], v[24:27], v[48:55], v152
    ds_read_b128 v[24:27], v154 offset:30160
    v_exp_f32 v60, v60
    v_exp_f32 v61, v61
    v_exp_f32 v62, v62
    v_exp_f32 v63, v63
    v_exp_f32 v32, v32
    v_exp_f32 v33, v33
    v_smfmac_f32_32x32x32_bf16 v[64:79], v[28:31], v[56:63], v152
    ds_read_b128 v[28:31], v155 offset:30160
    v_exp_f32 v34, v34
    v_exp_f32 v35, v35
    v_exp_f32 v36, v36
    v_exp_f32 v37, v37
    v_mfma_f32_32x32x16_bf16 v[48:63], v[8:11], v[16:19], 0
    ds_read_b128 v[8:11], v153 offset:30720
    v_exp_f32 v38, v38
    v_exp_f32 v39, v39
    v_exp_f32 v40, v40
    v_exp_f32 v41, v41
    v_exp_f32 v42, v42
    v_exp_f32 v43, v43
    s_waitcnt lgkmcnt(2)
    v_smfmac_f32_32x32x32_bf16 v[80:95], v[24:27], v[32:39], v152
    v_exp_f32 v44, v44
    v_exp_f32 v45, v45
    v_exp_f32 v46, v46
    v_exp_f32 v47, v47
    v_exp_f32 v48, v48
    v_exp_f32 v49, v49
    s_waitcnt lgkmcnt(0)
    v_smfmac_f32_32x32x32_bf16 v[80:95], v[28:31], v[40:47], v152
    v_exp_f32 v50, v50
    v_exp_f32 v51, v51
    v_exp_f32 v52, v52
    v_exp_f32 v53, v53
    v_mfma_f32_32x32x16_bf16 v[32:47], v[8:11], v[20:23], 0
    v_exp_f32 v54, v54
    v_exp_f32 v55, v55
    v_exp_f32 v56, v56
    v_exp_f32 v57, v57
    v_exp_f32 v58, v58
    v_exp_f32 v59, v59
    v_smfmac_f32_32x32x32_bf16 v[64:79], v[24:27], v[48:55], v152
    ds_read_b128 v[24:27], v154 offset:31200
    v_exp_f32 v60, v60
    v_exp_f32 v61, v61
    v_exp_f32 v62, v62
    v_exp_f32 v63, v63
    v_exp_f32 v32, v32
    v_exp_f32 v33, v33
    v_smfmac_f32_32x32x32_bf16 v[64:79], v[28:31], v[56:63], v152
    ds_read_b128 v[28:31], v155 offset:31200
    v_exp_f32 v34, v34
    v_exp_f32 v35, v35
    v_exp_f32 v36, v36
    v_exp_f32 v37, v37
    v_mfma_f32_32x32x16_bf16 v[48:63], v[8:11], v[16:19], 0
    ds_read_b128 v[8:11], v153 offset:31744
    v_exp_f32 v38, v38
    v_exp_f32 v39, v39
    v_exp_f32 v40, v40
    v_exp_f32 v41, v41
    v_exp_f32 v42, v42
    v_exp_f32 v43, v43
    s_waitcnt lgkmcnt(2)
    v_smfmac_f32_32x32x32_bf16 v[80:95], v[24:27], v[32:39], v152
    v_exp_f32 v44, v44
    v_exp_f32 v45, v45
    v_exp_f32 v46, v46
    v_exp_f32 v47, v47
    v_exp_f32 v48, v48
    v_exp_f32 v49, v49
    s_waitcnt lgkmcnt(0)
    v_smfmac_f32_32x32x32_bf16 v[80:95], v[28:31], v[40:47], v152
    v_exp_f32 v50, v50
    v_exp_f32 v51, v51
    v_exp_f32 v52, v52
    v_exp_f32 v53, v53
    v_mfma_f32_32x32x16_bf16 v[32:47], v[8:11], v[20:23], 0
    v_exp_f32 v54, v54
    v_exp_f32 v55, v55
    v_exp_f32 v56, v56
    v_exp_f32 v57, v57
    v_exp_f32 v58, v58
    v_exp_f32 v59, v59
    v_smfmac_f32_32x32x32_bf16 v[64:79], v[24:27], v[48:55], v152
    ds_read_b128 v[24:27], v154 offset:32240
    v_exp_f32 v60, v60
    v_exp_f32 v61, v61
    v_exp_f32 v62, v62
    v_exp_f32 v63, v63
    s_cmp_eq_u32 s75, 1
    s_cbranch_scc1 L_pr_22
L_pr_22_r:
    v_exp_f32 v32, v32
    v_exp_f32 v33, v33
    v_smfmac_f32_32x32x32_bf16 v[64:79], v[28:31], v[56:63], v152
    ds_read_b128 v[28:31], v155 offset:32240
    v_exp_f32 v34, v34
    v_exp_f32 v35, v35
    v_exp_f32 v36, v36
    v_exp_f32 v37, v37
    v_mfma_f32_32x32x16_bf16 v[48:63], v[8:11], v[16:19], 0
    v_exp_f32 v38, v38
    v_exp_f32 v39, v39
    v_exp_f32 v40, v40
    v_exp_f32 v41, v41
    v_exp_f32 v42, v42
    v_exp_f32 v43, v43
    s_waitcnt lgkmcnt(1)
    v_smfmac_f32_32x32x32_bf16 v[80:95], v[24:27], v[32:39], v152
    v_exp_f32 v44, v44
    v_exp_f32 v45, v45
    v_exp_f32 v46, v46
    v_exp_f32 v47, v47
    v_exp_f32 v48, v48
    v_exp_f32 v49, v49
    s_waitcnt lgkmcnt(0)
    v_smfmac_f32_32x32x32_bf16 v[80:95], v[28:31], v[40:47], v152
    v_exp_f32 v50, v50
    v_exp_f32 v51, v51
    v_exp_f32 v52, v52
    v_exp_f32 v53, v53
    v_exp_f32 v54, v54
    v_exp_f32 v55, v55
    v_exp_f32 v56, v56
    v_exp_f32 v57, v57
    v_exp_f32 v58, v58
    v_exp_f32 v59, v59
    v_smfmac_f32_32x32x32_bf16 v[64:79], v[24:27], v[48:55], v152
    s_add_u32 s74, s48, 0x600000
    ds_write_b128 v163, v[80:83]
    ds_write_b128 v163, v[84:87] offset:1024
    ds_write_b32 v164, v88 offset:2048
    ds_write_b32 v165, v5 offset:32
    v_exp_f32 v60, v60
    v_exp_f32 v61, v61
    v_exp_f32 v62, v62
    v_exp_f32 v63, v63
    s_nop 1
    v_smfmac_f32_32x32x32_bf16 v[64:79], v[28:31], v[56:63], v152
    s_setprio 3
L_xw_23:
    ds_read_b32 v6, v13 offset:32
    ds_read_b128 v[32:35], v14
    ds_read_b128 v[36:39], v14 offset:1024
    ds_read_b32 v40, v12 offset:2048
    s_nop 3
    s_waitcnt lgkmcnt(0)
    v_cmp_eq_u32 vcc, 0, v6
    s_cbranch_vccnz L_rt_25
L_xwd_24:
    v_add_f32 v72, v72, v40
    v_pk_add_f32 v[64:65], v[64:65], v[32:33]
    v_pk_add_f32 v[66:67], v[66:67], v[34:35]
    v_pk_add_f32 v[68:69], v[68:69], v[36:37]
    v_pk_add_f32 v[70:71], v[70:71], v[38:39]
    v_pk_add_f32 v[8:9], v[64:65], v[66:67]
    v_pk_add_f32 v[10:11], v[68:69], v[70:71]
    v_pk_add_f32 v[8:9], v[8:9], v[10:11]
    v_add_f32 v8, v8, v9
    v_fma_f32 v8, v8, 0, v72
    v_cmp_nle_f32 s[80:81], 1.0, v8
    v_cmp_nge_f32 vcc, s76, v8
    s_or_b64 vcc, vcc, s[80:81]
    s_cbranch_scc1 L_a_slow
L_a_fin:
    v_rcp_f32 v8, v72
    s_waitcnt vmcnt(0)
    v_mul_f32 v8, v8, v157
    v_pk_mul_f32 v[64:65], v[64:65], v[8:9] op_sel_hi:[1,0]
    v_pk_mul_f32 v[66:67], v[66:67], v[8:9] op_sel_hi:[1,0]
    v_pk_mul_f32 v[68:69], v[68:69], v[8:9] op_sel_hi:[1,0]
    v_pk_mul_f32 v[70:71], v[70:71], v[8:9] op_sel_hi:[1,0]
    v_cvt_pk_bf16_f32 v20, v64, v65
    v_cvt_pk_bf16_f32 v21, v66, v67
    v_cvt_pk_bf16_f32 v22, v68, v69
    v_cvt_pk_bf16_f32 v23, v70, v71
    v_min_u32 v20, -2, v20
    v_min_u32 v21, -2, v21
    v_min_u32 v22, -2, v22
    v_min_u32 v23, -2, v23
    buffer_store_dwordx4 v[20:23], v2, s[16:19], s74 offen sc1
    s_barrier
    s_endpgm
L_rt_12:
    s_sub_u32 s83, s83, 1
    s_cbranch_scc0 L_fw_10
    s_mov_b32 s83, 0
    s_branch L_fwd_11
L_pr_13:
    s_setprio 2
    s_branch L_pr_13_r
L_pr_14:
    s_setprio 2
    s_branch L_pr_14_r
L_rt_17:
    s_sleep 2
    s_sub_u32 s83, s83, 1
    s_cbranch_scc0 L_gp_15
    s_mov_b32 s83, 0
    s_branch L_gpd_16
L_a_gr:
    s_mov_b64 exec, 0x1
L_gp_15:
    buffer_load_dword v6, v158, s[16:19], s79 offen sc1
    s_waitcnt vmcnt(0)
    v_cmp_ne_u32 vcc, s70, v6
    s_cbranch_vccnz L_rt_17
L_gpd_16:
    s_mov_b64 exec, -1
    s_branch L_a_gk
L_rt_20:
    s_sub_u32 s83, s83, 1
    s_cbranch_scc0 L_lw_18
    s_mov_b32 s83, 0
    s_branch L_lwd_19
L_pr_21:
    s_setprio 1
    s_branch L_pr_21_r
L_pr_22:
    s_setprio 1
    s_branch L_pr_22_r
L_rt_25:
    s_sleep 1
    s_sub_u32 s83, s83, 1
    s_cbranch_scc0 L_xw_23
    s_mov_b32 s83, 0
    s_branch L_xwd_24
L_a_slow:
    v_mov_b32 v3, 0xff800000
    s_add_u32 s76, s78, 0x200000
    s_mov_b32 s79, 0
L_a_max:
    buffer_load_dwordx4 v[24:27], v2, s[16:19], s76 offen sc1
    s_waitcnt vmcnt(0)
    v_mfma_f32_32x32x16_bf16 v[32:47], v[24:27], v[16:19], 0
    s_add_u32 s76, s76, 1024
    s_nop 13
    v_max3_f32 v3, v32, v33, v3
    v_max3_f32 v3, v34, v35, v3
    v_max3_f32 v3, v36, v37, v3
    v_max3_f32 v3, v38, v39, v3
    v_max3_f32 v3, v40, v41, v3
    v_max3_f32 v3, v42, v43, v3
    v_max3_f32 v3, v44, v45, v3
    v_max3_f32 v3, v46, v47, v3
    s_add_u32 s79, s79, 1
    s_cmp_lt_u32 s79, 64
    s_cbranch_scc1 L_a_max
    v_mov_b32 v12, v3
    s_nop 1
    v_permlane32_swap_b32 v12, v3
    s_nop 1
    v_max_f32 v3, v12, v3
    v_sub_f32 v96, 0, v3
    v_sub_f32 v97, 0, v3
    v_sub_f32 v98, 0, v3
    v_sub_f32 v99, 0, v3
    v_sub_f32 v100, 0, v3
    v_sub_f32 v101, 0, v3
    v_sub_f32 v102, 0, v3
    v_sub_f32 v103, 0, v3
    v_sub_f32 v104, 0, v3
    v_sub_f32 v105, 0, v3
    v_sub_f32 v106, 0, v3
    v_sub_f32 v107, 0, v3
    v_sub_f32 v108, 0, v3
    v_sub_f32 v109, 0, v3
    v_sub_f32 v110, 0, v3
    v_sub_f32 v111, 0, v3
    v_mov_b32 v64, 0
    v_mov_b32 v65, 0
    v_mov_b32 v66, 0
    v_mov_b32 v67, 0
    v_mov_b32 v68, 0
    v_mov_b32 v69, 0
    v_mov_b32 v70, 0
    v_mov_b32 v71, 0
    v_mov_b32 v72, 0
    v_mov_b32 v73, 0
    v_mov_b32 v74, 0
    v_mov_b32 v75, 0
    v_mov_b32 v76, 0
    v_mov_b32 v77, 0
    v_mov_b32 v78, 0
    v_mov_b32 v79, 0
    v_and_b32 v3, 15, v1
    v_lshlrev_b32 v3, 4, v3
    v_lshrrev_b32 v12, 5, v1
    v_lshl_add_u32 v3, v12, 8, v3
    v_and_b32 v12, 16, v1
    v_cmp_eq_u32 vcc, 0, v12
    v_mov_b32 v12, 0x4000000
    v_mov_b32 v13, 0x3f803f80
    v_cndmask_b32 v3, v12, v3, vcc
    v_cndmask_b32 v13, v13, 0, vcc
    s_add_u32 s76, s78, 0x200000
    s_add_u32 s80, s78, 0x400000
    s_mov_b32 s79, 0
L_a_redo:
    buffer_load_dwordx4 v[48:51], v2, s[16:19], s76 offen sc1
    buffer_load_dwordx4 v[24:27], v3, s[16:19], s80 offen sc1
    buffer_load_dwordx4 v[28:31], v3, s[16:19], s80 offen offset:512 sc1
    s_waitcnt vmcnt(0)
    v_mfma_f32_32x32x16_bf16 v[32:47], v[48:51], v[16:19], v[96:111]
    s_add_u32 s76, s76, 1024
    s_add_u32 s80, s80, 1024
    v_or_b32 v24, v13, v24
    v_or_b32 v25, v13, v25
    v_or_b32 v26, v13, v26
    v_or_b32 v27, v13, v27
    v_or_b32 v28, v13, v28
    v_or_b32 v29, v13, v29
    v_or_b32 v30, v13, v30
    v_or_b32 v31, v13, v31
    s_nop 5
    v_exp_f32 v32, v32
    v_exp_f32 v33, v33
    v_exp_f32 v34, v34
    v_exp_f32 v35, v35
    v_exp_f32 v36, v36
    v_exp_f32 v37, v37
    v_exp_f32 v38, v38
    v_exp_f32 v39, v39
    v_exp_f32 v40, v40
    v_exp_f32 v41, v41
    v_exp_f32 v42, v42
    v_exp_f32 v43, v43
    v_exp_f32 v44, v44
    v_exp_f32 v45, v45
    v_exp_f32 v46, v46
    v_exp_f32 v47, v47
    s_nop 1
    v_smfmac_f32_32x32x32_bf16 v[64:79], v[24:27], v[32:39], v152
    v_smfmac_f32_32x32x32_bf16 v[64:79], v[28:31], v[40:47], v152
    s_add_u32 s79, s79, 1
    s_cmp_lt_u32 s79, 64
    s_cbranch_scc1 L_a_redo
    s_nop 13
    s_branch L_a_fin
L_codeend:
.section .rodata,"a"
.p2align 6
.amdhsa_kernel gated_mix__mha_block__glu_gated_glu__prompt_kernel
  .amdhsa_next_free_vgpr 168
  .amdhsa_next_free_sgpr 102
  .amdhsa_accum_offset 168
  .amdhsa_group_segment_fixed_size 0
  .amdhsa_kernarg_size 88
  .amdhsa_user_sgpr_count 2
  .amdhsa_user_sgpr_kernarg_segment_ptr 1
  .amdhsa_system_sgpr_workgroup_id_x 1
.end_amdhsa_kernel
```
